```python
import torch

def _softmax(x, axis=-1):
    return torch.softmax(x, dim=axis)
def _gelu(x):
    return torch.nn.functional.gelu(x, approximate="tanh")
def _silu(x):
    return torch.nn.functional.silu(x)
def _sigmoid(x):
    return torch.sigmoid(x)
def _layernorm(x, axis=-1, eps=1e-5):
    m = x.mean(dim=axis, keepdim=True)
    v = x.var(dim=axis, keepdim=True, unbiased=False)
    return (x - m) / torch.sqrt(v + eps)
def _scatter_add(tgt, idx, src, axis=0):
    return tgt.clone().index_add_(axis, idx, src)
def _segment_sum(src, seg, n):
    out = torch.zeros((n,) + src.shape[1:], dtype=src.dtype)
    return out.index_add_(0, seg, src)
def _pad(x, pw):
    flat = tuple(v for pair in reversed(pw) for v in pair)
    return torch.nn.functional.pad(x, flat)

kernel_name = 'concat_heads__grouped_kv_mqa__softmax_full_mha__prompt'

def setup_inputs():

    _w = (lambda a: (lambda t: t.to(torch.bfloat16) if t.is_floating_point() else t)(torch.as_tensor(a)))
    def _A_setup():
        B, S, D, H = 1, 2048, 1024, 32
        Dh = D // H
        return {
            "x": _w((lambda *s: torch.randn(*s, dtype=torch.bfloat16) * 0.05)(B, S, D)),
            "wq": _w((lambda *s: torch.randn(*s, dtype=torch.bfloat16) * 0.8)(D, H * Dh)),
            "wk": _w((lambda *s: torch.randn(*s, dtype=torch.bfloat16) * 0.8)(D, Dh)),
            "wv": _w((lambda *s: torch.randn(*s, dtype=torch.bfloat16) * 0.1)(D, Dh)),
            "wo": _w((lambda *s: torch.randn(*s, dtype=torch.bfloat16) * 0.1)(H * Dh, D)),
        }
    _A_in = _A_setup()

    def _B_setup():
        B, S, D = 1, 2048, 1024
        return {
            "x": _w((lambda *s: torch.randn(*s, dtype=torch.bfloat16) * 0.2)(B, S, D)),
            "wqkv": _w((lambda *s: torch.randn(*s, dtype=torch.bfloat16) * 0.2)(D, 3 * D)),
            "wo": _w((lambda *s: torch.randn(*s, dtype=torch.bfloat16) * 0.05)(D, D)),
        }
    _B_in = _B_setup()

    return {
        "A_x": _A_in["x"],
        "A_wq": _A_in["wq"],
        "A_wk": _A_in["wk"],
        "A_wv": _A_in["wv"],
        "A_wo": _A_in["wo"],
        "B_x": _B_in["x"],
        "B_wqkv": _B_in["wqkv"],
        "B_wo": _B_in["wo"],
    }

def reference(A_x, A_wq, A_wk, A_wv, A_wo, B_x, B_wqkv, B_wo):
    def _A_ref(x, wq, wk, wv, wo):
        B, S, D = x.shape
        H = 32
        Dh = D // H
        q = (lambda x, *d: x.permute(*d))((x @ wq).reshape(B, S, H, Dh), 0, 2, 1, 3)
        k = x @ wk
        v = x @ wv
        scores = torch.einsum("bhqd,bkd->bhqk", q, k) * (Dh ** -0.5)
        p = _softmax(scores, axis=-1)
        o = torch.einsum("bhqk,bkd->bhqd", p, v)
        return (lambda x, *d: x.permute(*d))(o, 0, 2, 1, 3).reshape(B, S, H * Dh) @ wo

    def _B_ref(x, wqkv, wo):
        B, S, D = x.shape
        H = 32; Dh = D // H
        qkv = (lambda x, *d: x.permute(*d))((x @ wqkv).reshape(B, S, 3, H, Dh), 2, 0, 3, 1, 4)
        q, k, v = qkv[0], qkv[1], qkv[2]
        scale = Dh ** -0.5
        scores = torch.einsum("bhqd,bhkd->bhqk", q, k) * scale
        p = _softmax(scores, axis=-1)
        o = torch.einsum("bhqk,bhkd->bhqd", p, v)
        return (lambda x, *d: x.permute(*d))(o, 0, 2, 1, 3).reshape(B, S, D) @ wo

    a = _A_ref(A_x, A_wq, A_wk, A_wv, A_wo)
    b = _B_ref(B_x, B_wqkv, B_wo)
    return torch.concatenate([a, b], axis=-1)
```

```asm
; @launch grid=(256,1,1) block=(512,1,1) lds=147456
.amdgcn_target "amdgcn-amd-amdhsa--gfx950"
.text
.globl concat_heads__grouped_kv_mqa__softmax_full_mha__prompt_kernel
.p2align 8
.type concat_heads__grouped_kv_mqa__softmax_full_mha__prompt_kernel,@function
concat_heads__grouped_kv_mqa__softmax_full_mha__prompt_kernel:
    s_cmp_ge_u32 s2, 256
    s_cbranch_scc1 KF_END
    s_load_dwordx16 s[16:31], s[0:1], 0
    s_load_dwordx4 s[56:59], s[0:1], 64
    s_load_dwordx2 s[32:33], s[0:1], 80
    s_getpc_b64 s[76:77]
KF_PC:
    s_and_b32 s77, s77, 0xffff
    s_mov_b32 s78, CODE_END - KF_PC
    s_mov_b32 s79, 0x20000
    v_lshlrev_b32 v1, 4, v0
    s_mov_b32 s10, 8192
    s_mov_b32 s11, 16384
    s_mov_b32 s12, 24576
    s_mov_b32 s13, 32768
    buffer_load_dwordx4 v[250:253], v1, s[76:79], 0 offen
    buffer_load_dwordx4 v[250:253], v1, s[76:79], s10 offen
    buffer_load_dwordx4 v[250:253], v1, s[76:79], s11 offen
    buffer_load_dwordx4 v[250:253], v1, s[76:79], s12 offen
    buffer_load_dwordx4 v[250:253], v1, s[76:79], s13 offen
    v_lshrrev_b32 v2, 6, v0
    v_and_b32 v0, 63, v0
    s_and_b32 s10, s2, 7
    v_readfirstlane_b32 s8, v2
    v_lshlrev_b32 v1, 4, v0
    s_lshr_b32 s4, s2, 3
    s_and_b32 s5, s10, 1
    s_lshr_b32 s13, s4, 2
    s_and_b32 s14, s4, 3
    s_and_b32 s11, s10, 2
    s_lshl_b32 s6, s11, 2
    s_add_u32 s6, s6, s13
    s_and_b32 s3, s10, 4
    s_add_u32 s3, s3, s14
    s_add_u32 s4, s13, s14
    s_lshr_b32 s9, s3, 2
    s_add_u32 s9, s9, 1
    s_lshr_b32 s7, s6, 3
    s_xor_b32 s7, s7, s5
    s_lshl_b32 s7, s7, 2
    s_add_u32 s7, s7, s14
    s_lshl_b32 s10, s3, 8
    s_lshl_b32 s11, s9, 11
    s_lshl_b32 s13, s7, 8
    s_add_u32 s11, s11, s13
    s_lshl_b32 s68, s6, 18
    s_mov_b32 s64, 6144
    s_mov_b32 s42, 0x600000
    s_cmp_eq_u32 s5, 1
    s_cselect_b32 s15, 0, s9
    s_cselect_b32 s67, s9, 0
    s_cselect_b32 s70, s10, s11
    s_cselect_b32 s71, s11, s10
    s_cselect_b32 s64, 2048, s64
    s_cselect_b32 s42, 0x200000, s42
    s_mov_b32 s38, 0x400000
    s_mov_b32 s39, 0x20000
    s_mov_b32 s43, 0x20000
    s_sub_u32 s13, s8, 4
    v_lshrrev_b32 v3, 4, v0
    s_and_b32 s10, s13, 1
    s_lshl_b32 s10, s10, 2
    v_add_u32 v5, s10, v3
    v_and_b32 v6, 7, v0
    v_xor_b32 v5, v5, v6
    v_lshlrev_b32 v5, 4, v5
    v_lshrrev_b32 v6, 3, v0
    v_lshl_add_u32 v10, v6, 11, v5
    v_lshrrev_b32 v6, 1, v0
    v_and_b32 v6, 7, v6
    v_xor_b32 v6, v6, v3
    v_lshlrev_b32 v6, 5, v6
    v_and_b32 v7, 1, v0
    v_lshl_add_u32 v6, v7, 4, v6
    v_mul_u32_u24 v7, s64, v3
    v_add_u32 v11, v6, v7
    v_xor_b32 v12, 128, v11
    s_lshl_b32 s10, s13, 14
    s_add_u32 s68, s68, s10
    s_lshl_b32 s10, s13, 4
    s_mul_i32 s11, s10, s64
    s_add_u32 s70, s70, s11
    s_mul_i32 s11, s10, 6144
    s_add_u32 s71, s71, s11
    s_lshl_b32 s65, s13, 10
    s_lshl_b32 s66, s13, 12
    s_add_u32 s66, s66, 16384
    s_mov_b32 s73, 0
    s_mov_b32 s74, 0
    s_and_b32 s75, s4, 3
    s_and_b32 s96, s3, 3
    s_add_u32 s96, s96, s4
    s_and_b32 s97, s4, 1
    s_mov_b32 s14, 0
    s_cmp_eq_u32 s5, 1
    s_waitcnt lgkmcnt(0)
    s_cselect_b32 s36, s16, s26
    s_cselect_b32 s37, s17, s27
    s_cselect_b32 s40, s18, s28
    s_cselect_b32 s41, s19, s29
    s_cselect_b32 s24, s24, s30
    s_cselect_b32 s25, s25, s31
    s_and_b32 s37, s37, 0xffff
    s_and_b32 s41, s41, 0xffff
    s_mov_b32 s60, s58
    s_and_b32 s61, s59, 0xffff
    s_mov_b32 s62, 256
    s_mov_b32 s63, 0x20000
    s_cmp_lt_u32 s8, 4
    s_cbranch_scc1 KF_COMP
    s_setprio 3
    s_mov_b64 s[34:35], s[56:57]
    s_bitcmp1_b32 s3, 0
    s_cselect_b32 s56, s22, s20
    s_cselect_b32 s57, s23, s21
    s_and_b32 s57, s57, 0xffff
    s_mov_b32 s58, 0x10000
    s_mov_b32 s59, 0x20000
    s_cmp_eq_u32 s5, 0
    s_cbranch_scc1 KF_LB
    s_add_u32 s10, s14, s75
    s_and_b32 s10, s10, 3
    s_and_b32 s11, s14, 12
    s_or_b32 s10, s10, s11
    s_lshl_b32 s11, s10, 7
    s_add_u32 s11, s11, s68
    s_add_u32 m0, s65, s73
    s_lshl_b32 s12, s10, 6
    buffer_load_dwordx4 v10, s[36:39], s11 offen lds
    s_add_u32 m0, m0, 4096
    s_add_u32 s11, s11, 65536
    buffer_load_dwordx4 v10, s[36:39], s11 offen lds
    s_add_u32 m0, m0, 4096
    s_add_u32 s11, s11, 65536
    buffer_load_dwordx4 v10, s[36:39], s11 offen lds
    s_add_u32 m0, m0, 4096
    s_add_u32 s11, s11, 65536
    buffer_load_dwordx4 v10, s[36:39], s11 offen lds
    s_mul_i32 s12, s12, s64
    s_lshl_b32 s15, s64, 2
    s_add_u32 m0, s66, s73
    s_add_u32 s12, s12, s70
    buffer_load_dwordx4 v11, s[40:43], s12 offen lds
    s_add_u32 m0, m0, 1024
    s_add_u32 s12, s12, s15
    buffer_load_dwordx4 v11, s[40:43], s12 offen lds
    s_add_u32 m0, m0, 1024
    s_add_u32 s12, s12, s15
    buffer_load_dwordx4 v12, s[40:43], s12 offen lds
    s_add_u32 m0, m0, 1024
    s_add_u32 s12, s12, s15
    buffer_load_dwordx4 v12, s[40:43], s12 offen lds
    s_lshr_b32 s11, s73, 3
    s_add_u32 s11, s11, s65
    s_add_u32 m0, s11, 131072
    s_lshl_b32 s10, s10, 12
    s_add_u32 s10, s10, s65
    buffer_load_dwordx4 v1, s[56:59], s10 offen lds
    s_add_u32 s14, s14, 1
    s_add_u32 s73, s73, 32768
    s_and_b32 s73, s73, 131071
    s_add_u32 s10, s14, s75
    s_and_b32 s10, s10, 3
    s_and_b32 s11, s14, 12
    s_or_b32 s10, s10, s11
    s_lshl_b32 s11, s10, 7
    s_add_u32 s11, s11, s68
    s_add_u32 m0, s65, s73
    s_lshl_b32 s12, s10, 6
    buffer_load_dwordx4 v10, s[36:39], s11 offen lds
    s_add_u32 m0, m0, 4096
    s_add_u32 s11, s11, 65536
    buffer_load_dwordx4 v10, s[36:39], s11 offen lds
    s_add_u32 m0, m0, 4096
    s_add_u32 s11, s11, 65536
    buffer_load_dwordx4 v10, s[36:39], s11 offen lds
    s_add_u32 m0, m0, 4096
    s_add_u32 s11, s11, 65536
    buffer_load_dwordx4 v10, s[36:39], s11 offen lds
    s_mul_i32 s12, s12, s64
    s_lshl_b32 s15, s64, 2
    s_add_u32 m0, s66, s73
    s_add_u32 s12, s12, s70
    buffer_load_dwordx4 v11, s[40:43], s12 offen lds
    s_add_u32 m0, m0, 1024
    s_add_u32 s12, s12, s15
    buffer_load_dwordx4 v11, s[40:43], s12 offen lds
    s_add_u32 m0, m0, 1024
    s_add_u32 s12, s12, s15
    buffer_load_dwordx4 v12, s[40:43], s12 offen lds
    s_add_u32 m0, m0, 1024
    s_add_u32 s12, s12, s15
    buffer_load_dwordx4 v12, s[40:43], s12 offen lds
    s_lshr_b32 s11, s73, 3
    s_add_u32 s11, s11, s65
    s_add_u32 m0, s11, 131072
    s_lshl_b32 s10, s10, 12
    s_add_u32 s10, s10, s65
    buffer_load_dwordx4 v1, s[56:59], s10 offen lds
    s_add_u32 s14, s14, 1
    s_add_u32 s73, s73, 32768
    s_and_b32 s73, s73, 131071
    v_mul_u32_u24 v7, 6144, v3
    v_add_u32 v16, v6, v7
    v_xor_b32 v17, 128, v16
    v_and_b32 v44, 7, v0
    s_lshl_b32 s10, s5, 5
    v_add_u32 v44, s10, v44
    v_lshlrev_b32 v44, 2, v44
    s_mov_b32 s69, s13
    s_mov_b32 s44, s26
    s_and_b32 s45, s27, 0xffff
    s_mov_b32 s46, 4194304
    s_mov_b32 s47, 0x20000
    s_mov_b32 s48, s28
    s_and_b32 s49, s29, 0xffff
    s_mov_b32 s50, 6291456
    s_mov_b32 s51, 0x20000
    s_mov_b32 s52, s32
    s_and_b32 s53, s33, 0xffff
    s_mov_b32 s54, 21004288
    s_mov_b32 s55, 0x20000
    s_and_b32 s25, s25, 0xffff
    s_mov_b32 s26, 0x200000
    s_mov_b32 s27, 0x20000
    s_mov_b32 s28, s34
    s_and_b32 s29, s35, 0xffff
    s_mov_b32 s30, 0x800000
    s_mov_b32 s31, 0x20000
    s_and_b32 s10, s8, 2
    s_lshr_b32 s11, s8, 2
    s_add_u32 s88, s10, s11
    s_and_b32 s89, s8, 1
    s_lshl_b32 s10, s88, 13
    s_lshl_b32 s11, s89, 12
    s_add_u32 s92, s10, s11
    s_lshl_b32 s12, s3, 2
    s_add_u32 s12, s12, s88
    s_lshl_b32 s13, s8, 10
    s_cmp_eq_u32 s5, 1
    s_cselect_b32 s93, 0, s10
    s_cselect_b32 s18, 32, s12
    s_cselect_b32 s16, s13, s92
    s_cselect_b32 s20, s13, s11
    s_cselect_b32 s23, 0, 64
    s_lshl_b32 s18, s18, 18
    s_add_u32 s18, s18, 0
    s_add_u32 s80, s32, s18
    s_addc_u32 s81, s33, 0
    s_and_b32 s81, s81, 0xffff
    s_mov_b32 s82, 0x40000
    s_mov_b32 s83, 0x20000
    s_add_u32 s20, s20, 24576
    s_and_b32 s21, s3, 4
    s_lshl_b32 s21, s21, 15
    s_add_u32 s84, s16, 98304
    s_mov_b32 s85, s16
    s_add_u32 s86, s16, 32768
    s_add_u32 s87, s16, 65536
    s_lshl_b32 s13, s6, 2
    s_add_u32 s23, s23, s13
    s_lshl_b32 s94, s23, 16
    s_lshl_b32 s13, s89, 1
    s_add_u32 s23, s23, s13
    s_lshl_b32 s23, s23, 6
    s_lshl_b32 s12, s12, 1
    s_add_u32 s23, s23, s12
    s_lshl_b32 s23, s23, 10
    s_add_u32 s23, s23, 12582912
    s_lshl_b32 s10, s5, 4
    s_add_u32 s10, s10, s6
    s_lshl_b32 s95, s10, 10
    s_add_u32 s95, s95, 20971520
    s_mov_b32 s91, 0x71800000
    s_mov_b32 s13, s69
    s_cmp_lg_u32 s13, 0
    s_cbranch_scc1 KF_NCLR_1
    s_lshl_b32 s10, s3, 7
    s_add_u32 s10, s10, s95
    v_mov_b32 v45, 0
    v_lshlrev_b32 v46, 2, v0
    s_mov_b64 exec, 0xff
    buffer_store_dword v45, v46, s[52:55], s10 offen sc0 sc1
    s_mov_b64 exec, -1
KF_NCLR_1:
    v_and_b32 v4, 3, v0
    s_lshr_b32 s10, s3, 1
    s_lshl_b32 s10, s10, 5
    s_and_b32 s11, s13, 1
    s_lshl_b32 s11, s11, 4
    s_add_u32 s10, s10, s11
    v_and_b32 v18, 15, v0
    v_add_u32 v19, s10, v18
    v_lshrrev_b32 v20, 1, v18
    v_xor_b32 v20, v20, v3
    v_lshlrev_b32 v20, 4, v20
    v_lshl_add_u32 v14, v19, 7, v20
    v_lshrrev_b32 v20, 2, v18
    v_lshl_add_u32 v20, v3, 3, v20
    v_lshlrev_b32 v20, 6, v20
    v_lshl_add_u32 v20, v4, 3, v20
    s_lshr_b32 s10, s13, 1
    s_lshl_b32 s10, s10, 5
    s_add_u32 s10, s10, 131072
    v_add_u32 v15, s10, v20
    v_mov_b32 v40, 0
    v_mov_b32 v41, 0
    v_mov_b32 v42, 0
    v_mov_b32 v43, 0
    s_waitcnt vmcnt(9)
    s_barrier
    v_add_u32 v20, s74, v14
    v_xor_b32 v22, 64, v20
    s_lshr_b32 s10, s74, 3
    v_add_u32 v21, s10, v15
    ds_read_b128 v[24:27], v20
    ds_read_b64_tr_b16 v[28:29], v21
    ds_read_b64_tr_b16 v[30:31], v21 offset:256
    ds_read_b128 v[32:35], v22
    ds_read_b64_tr_b16 v[36:37], v21 offset:2048
    ds_read_b64_tr_b16 v[38:39], v21 offset:2304
    s_add_u32 s74, s74, 32768
    s_and_b32 s74, s74, 131071
    s_add_u32 s10, s14, s75
    s_and_b32 s10, s10, 3
    s_and_b32 s11, s14, 12
    s_or_b32 s10, s10, s11
    s_lshl_b32 s11, s10, 7
    s_add_u32 s11, s11, s68
    s_add_u32 m0, s65, s73
    s_lshl_b32 s12, s10, 6
    buffer_load_dwordx4 v10, s[36:39], s11 offen lds
    s_add_u32 m0, m0, 4096
    s_add_u32 s11, s11, 65536
    buffer_load_dwordx4 v10, s[36:39], s11 offen lds
    s_add_u32 m0, m0, 4096
    s_add_u32 s11, s11, 65536
    buffer_load_dwordx4 v10, s[36:39], s11 offen lds
    s_add_u32 m0, m0, 4096
    s_add_u32 s11, s11, 65536
    buffer_load_dwordx4 v10, s[36:39], s11 offen lds
    s_mul_i32 s12, s12, s64
    s_lshl_b32 s15, s64, 2
    s_add_u32 m0, s66, s73
    s_add_u32 s12, s12, s70
    buffer_load_dwordx4 v11, s[40:43], s12 offen lds
    s_add_u32 m0, m0, 1024
    s_add_u32 s12, s12, s15
    buffer_load_dwordx4 v11, s[40:43], s12 offen lds
    s_add_u32 m0, m0, 1024
    s_add_u32 s12, s12, s15
    buffer_load_dwordx4 v12, s[40:43], s12 offen lds
    s_add_u32 m0, m0, 1024
    s_add_u32 s12, s12, s15
    buffer_load_dwordx4 v12, s[40:43], s12 offen lds
    s_lshr_b32 s11, s73, 3
    s_add_u32 s11, s11, s65
    s_add_u32 m0, s11, 131072
    s_lshl_b32 s10, s10, 12
    s_add_u32 s10, s10, s65
    buffer_load_dwordx4 v1, s[56:59], s10 offen lds
    s_add_u32 s14, s14, 1
    s_add_u32 s73, s73, 32768
    s_and_b32 s73, s73, 131071
    s_add_u32 s10, s14, s75
    s_and_b32 s10, s10, 3
    s_and_b32 s11, s14, 12
    s_or_b32 s10, s10, s11
    s_lshl_b32 s11, s10, 7
    s_add_u32 s11, s11, s68
    s_add_u32 m0, s65, s73
    s_lshl_b32 s12, s10, 6
    buffer_load_dwordx4 v10, s[36:39], s11 offen lds
    s_add_u32 m0, m0, 4096
    s_add_u32 s11, s11, 65536
    buffer_load_dwordx4 v10, s[36:39], s11 offen lds
    s_add_u32 m0, m0, 4096
    s_add_u32 s11, s11, 65536
    buffer_load_dwordx4 v10, s[36:39], s11 offen lds
    s_add_u32 m0, m0, 4096
    s_add_u32 s11, s11, 65536
    buffer_load_dwordx4 v10, s[36:39], s11 offen lds
    s_mul_i32 s12, s12, s64
    s_lshl_b32 s15, s64, 2
    s_add_u32 m0, s66, s73
    s_add_u32 s12, s12, s70
    buffer_load_dwordx4 v11, s[40:43], s12 offen lds
    s_add_u32 m0, m0, 1024
    s_add_u32 s12, s12, s15
    buffer_load_dwordx4 v11, s[40:43], s12 offen lds
    s_add_u32 m0, m0, 1024
    s_add_u32 s12, s12, s15
    buffer_load_dwordx4 v12, s[40:43], s12 offen lds
    s_add_u32 m0, m0, 1024
    s_add_u32 s12, s12, s15
    buffer_load_dwordx4 v12, s[40:43], s12 offen lds
    s_lshr_b32 s11, s73, 3
    s_add_u32 s11, s11, s65
    s_add_u32 m0, s11, 131072
    s_lshl_b32 s10, s10, 12
    s_add_u32 s10, s10, s65
    buffer_load_dwordx4 v1, s[56:59], s10 offen lds
    s_add_u32 s14, s14, 1
    s_add_u32 s73, s73, 32768
    s_and_b32 s73, s73, 131071
    s_waitcnt vmcnt(18) lgkmcnt(0)
    s_mov_b32 s67, 12
KF_L11:
    s_barrier
    s_bitcmp1_b32 s3, 0
    s_cbranch_scc1 KF_XV_2
    v_mfma_f32_16x16x32_bf16 v[40:43], v[28:31], v[24:27], v[40:43]
    v_mfma_f32_16x16x32_bf16 v[40:43], v[36:39], v[32:35], v[40:43]
    s_branch KF_XD_3
KF_XV_2:
    v_mfma_f32_16x16x32_bf16 v[40:43], v[24:27], v[28:31], v[40:43]
    v_mfma_f32_16x16x32_bf16 v[40:43], v[32:35], v[36:39], v[40:43]
KF_XD_3:
    v_add_u32 v20, s74, v14
    v_xor_b32 v22, 64, v20
    s_lshr_b32 s10, s74, 3
    v_add_u32 v21, s10, v15
    ds_read_b128 v[24:27], v20
    ds_read_b64_tr_b16 v[28:29], v21
    ds_read_b64_tr_b16 v[30:31], v21 offset:256
    ds_read_b128 v[32:35], v22
    ds_read_b64_tr_b16 v[36:37], v21 offset:2048
    ds_read_b64_tr_b16 v[38:39], v21 offset:2304
    s_add_u32 s74, s74, 32768
    s_and_b32 s74, s74, 131071
    s_add_u32 s10, s14, s75
    s_and_b32 s10, s10, 3
    s_and_b32 s11, s14, 12
    s_or_b32 s10, s10, s11
    s_lshl_b32 s11, s10, 7
    s_add_u32 s11, s11, s68
    s_add_u32 m0, s65, s73
    s_lshl_b32 s12, s10, 6
    buffer_load_dwordx4 v10, s[36:39], s11 offen lds
    s_add_u32 m0, m0, 4096
    s_add_u32 s11, s11, 65536
    buffer_load_dwordx4 v10, s[36:39], s11 offen lds
    s_add_u32 m0, m0, 4096
    s_add_u32 s11, s11, 65536
    buffer_load_dwordx4 v10, s[36:39], s11 offen lds
    s_add_u32 m0, m0, 4096
    s_add_u32 s11, s11, 65536
    buffer_load_dwordx4 v10, s[36:39], s11 offen lds
    s_mul_i32 s12, s12, s64
    s_lshl_b32 s15, s64, 2
    s_add_u32 m0, s66, s73
    s_add_u32 s12, s12, s70
    buffer_load_dwordx4 v11, s[40:43], s12 offen lds
    s_add_u32 m0, m0, 1024
    s_add_u32 s12, s12, s15
    buffer_load_dwordx4 v11, s[40:43], s12 offen lds
    s_add_u32 m0, m0, 1024
    s_add_u32 s12, s12, s15
    buffer_load_dwordx4 v12, s[40:43], s12 offen lds
    s_add_u32 m0, m0, 1024
    s_add_u32 s12, s12, s15
    buffer_load_dwordx4 v12, s[40:43], s12 offen lds
    s_lshr_b32 s11, s73, 3
    s_add_u32 s11, s11, s65
    s_add_u32 m0, s11, 131072
    s_lshl_b32 s10, s10, 12
    s_add_u32 s10, s10, s65
    buffer_load_dwordx4 v1, s[56:59], s10 offen lds
    s_add_u32 s14, s14, 1
    s_add_u32 s73, s73, 32768
    s_and_b32 s73, s73, 131071
    s_sub_u32 s67, s67, 1
    s_cmp_lg_u32 s67, 0
    s_waitcnt vmcnt(18) lgkmcnt(0)
    s_cbranch_scc1 KF_L11
    s_mov_b32 s14, 0
    s_barrier
    s_bitcmp1_b32 s3, 0
    s_cbranch_scc1 KF_XV_4
    v_mfma_f32_16x16x32_bf16 v[40:43], v[28:31], v[24:27], v[40:43]
    v_mfma_f32_16x16x32_bf16 v[40:43], v[36:39], v[32:35], v[40:43]
    s_branch KF_XD_5
KF_XV_4:
    v_mfma_f32_16x16x32_bf16 v[40:43], v[24:27], v[28:31], v[40:43]
    v_mfma_f32_16x16x32_bf16 v[40:43], v[32:35], v[36:39], v[40:43]
KF_XD_5:
    v_add_u32 v20, s74, v14
    v_xor_b32 v22, 64, v20
    s_lshr_b32 s10, s74, 3
    v_add_u32 v21, s10, v15
    ds_read_b128 v[24:27], v20
    ds_read_b64_tr_b16 v[28:29], v21
    ds_read_b64_tr_b16 v[30:31], v21 offset:256
    ds_read_b128 v[32:35], v22
    ds_read_b64_tr_b16 v[36:37], v21 offset:2048
    ds_read_b64_tr_b16 v[38:39], v21 offset:2304
    s_add_u32 s74, s74, 32768
    s_and_b32 s74, s74, 131071
    s_add_u32 s10, s14, s75
    s_and_b32 s10, s10, 3
    s_and_b32 s11, s14, 12
    s_or_b32 s10, s10, s11
    s_lshl_b32 s11, s10, 7
    s_add_u32 s11, s11, s68
    s_add_u32 m0, s65, s73
    s_lshl_b32 s12, s10, 6
    buffer_load_dwordx4 v10, s[44:47], s11 offen lds
    s_add_u32 m0, m0, 4096
    s_add_u32 s11, s11, 65536
    buffer_load_dwordx4 v10, s[44:47], s11 offen lds
    s_add_u32 m0, m0, 4096
    s_add_u32 s11, s11, 65536
    buffer_load_dwordx4 v10, s[44:47], s11 offen lds
    s_add_u32 m0, m0, 4096
    s_add_u32 s11, s11, 65536
    buffer_load_dwordx4 v10, s[44:47], s11 offen lds
    s_mul_i32 s12, s12, 6144
    s_mov_b32 s15, 24576
    s_add_u32 m0, s66, s73
    s_add_u32 s12, s12, s71
    buffer_load_dwordx4 v16, s[48:51], s12 offen lds
    s_add_u32 m0, m0, 1024
    s_add_u32 s12, s12, s15
    buffer_load_dwordx4 v16, s[48:51], s12 offen lds
    s_add_u32 m0, m0, 1024
    s_add_u32 s12, s12, s15
    buffer_load_dwordx4 v17, s[48:51], s12 offen lds
    s_add_u32 m0, m0, 1024
    s_add_u32 s12, s12, s15
    buffer_load_dwordx4 v17, s[48:51], s12 offen lds
    s_add_u32 s14, s14, 1
    s_add_u32 s73, s73, 32768
    s_and_b32 s73, s73, 131071
    s_waitcnt vmcnt(17) lgkmcnt(0)
    s_barrier
    s_bitcmp1_b32 s3, 0
    s_cbranch_scc1 KF_XV_6
    v_mfma_f32_16x16x32_bf16 v[40:43], v[28:31], v[24:27], v[40:43]
    v_mfma_f32_16x16x32_bf16 v[40:43], v[36:39], v[32:35], v[40:43]
    s_branch KF_XD_7
KF_XV_6:
    v_mfma_f32_16x16x32_bf16 v[40:43], v[24:27], v[28:31], v[40:43]
    v_mfma_f32_16x16x32_bf16 v[40:43], v[32:35], v[36:39], v[40:43]
KF_XD_7:
    v_add_u32 v20, s74, v14
    v_xor_b32 v22, 64, v20
    s_lshr_b32 s10, s74, 3
    v_add_u32 v21, s10, v15
    ds_read_b128 v[24:27], v20
    ds_read_b64_tr_b16 v[28:29], v21
    ds_read_b64_tr_b16 v[30:31], v21 offset:256
    ds_read_b128 v[32:35], v22
    ds_read_b64_tr_b16 v[36:37], v21 offset:2048
    ds_read_b64_tr_b16 v[38:39], v21 offset:2304
    s_add_u32 s74, s74, 32768
    s_and_b32 s74, s74, 131071
    s_add_u32 s10, s14, s75
    s_and_b32 s10, s10, 3
    s_and_b32 s11, s14, 12
    s_or_b32 s10, s10, s11
    s_lshl_b32 s11, s10, 7
    s_add_u32 s11, s11, s68
    s_add_u32 m0, s65, s73
    s_lshl_b32 s12, s10, 6
    buffer_load_dwordx4 v10, s[44:47], s11 offen lds
    s_add_u32 m0, m0, 4096
    s_add_u32 s11, s11, 65536
    buffer_load_dwordx4 v10, s[44:47], s11 offen lds
    s_add_u32 m0, m0, 4096
    s_add_u32 s11, s11, 65536
    buffer_load_dwordx4 v10, s[44:47], s11 offen lds
    s_add_u32 m0, m0, 4096
    s_add_u32 s11, s11, 65536
    buffer_load_dwordx4 v10, s[44:47], s11 offen lds
    s_mul_i32 s12, s12, 6144
    s_mov_b32 s15, 24576
    s_add_u32 m0, s66, s73
    s_add_u32 s12, s12, s71
    buffer_load_dwordx4 v16, s[48:51], s12 offen lds
    s_add_u32 m0, m0, 1024
    s_add_u32 s12, s12, s15
    buffer_load_dwordx4 v16, s[48:51], s12 offen lds
    s_add_u32 m0, m0, 1024
    s_add_u32 s12, s12, s15
    buffer_load_dwordx4 v17, s[48:51], s12 offen lds
    s_add_u32 m0, m0, 1024
    s_add_u32 s12, s12, s15
    buffer_load_dwordx4 v17, s[48:51], s12 offen lds
    s_add_u32 s14, s14, 1
    s_add_u32 s73, s73, 32768
    s_and_b32 s73, s73, 131071
    s_waitcnt vmcnt(16) lgkmcnt(0)
    s_barrier
    s_bitcmp1_b32 s3, 0
    s_cbranch_scc1 KF_XV_8
    v_mfma_f32_16x16x32_bf16 v[40:43], v[28:31], v[24:27], v[40:43]
    v_mfma_f32_16x16x32_bf16 v[40:43], v[36:39], v[32:35], v[40:43]
    s_branch KF_XD_9
KF_XV_8:
    v_mfma_f32_16x16x32_bf16 v[40:43], v[24:27], v[28:31], v[40:43]
    v_mfma_f32_16x16x32_bf16 v[40:43], v[32:35], v[36:39], v[40:43]
KF_XD_9:
    v_add_u32 v20, s74, v14
    v_xor_b32 v22, 64, v20
    s_lshr_b32 s10, s74, 3
    v_add_u32 v21, s10, v15
    ds_read_b128 v[24:27], v20
    ds_read_b64_tr_b16 v[28:29], v21
    ds_read_b64_tr_b16 v[30:31], v21 offset:256
    ds_read_b128 v[32:35], v22
    ds_read_b64_tr_b16 v[36:37], v21 offset:2048
    ds_read_b64_tr_b16 v[38:39], v21 offset:2304
    s_add_u32 s74, s74, 32768
    s_and_b32 s74, s74, 131071
    s_add_u32 s10, s14, s75
    s_and_b32 s10, s10, 3
    s_and_b32 s11, s14, 12
    s_or_b32 s10, s10, s11
    s_lshl_b32 s11, s10, 7
    s_add_u32 s11, s11, s68
    s_add_u32 m0, s65, s73
    s_lshl_b32 s12, s10, 6
    buffer_load_dwordx4 v10, s[44:47], s11 offen lds
    s_add_u32 m0, m0, 4096
    s_add_u32 s11, s11, 65536
    buffer_load_dwordx4 v10, s[44:47], s11 offen lds
    s_add_u32 m0, m0, 4096
    s_add_u32 s11, s11, 65536
    buffer_load_dwordx4 v10, s[44:47], s11 offen lds
    s_add_u32 m0, m0, 4096
    s_add_u32 s11, s11, 65536
    buffer_load_dwordx4 v10, s[44:47], s11 offen lds
    s_mul_i32 s12, s12, 6144
    s_mov_b32 s15, 24576
    s_add_u32 m0, s66, s73
    s_add_u32 s12, s12, s71
    buffer_load_dwordx4 v16, s[48:51], s12 offen lds
    s_add_u32 m0, m0, 1024
    s_add_u32 s12, s12, s15
    buffer_load_dwordx4 v16, s[48:51], s12 offen lds
    s_add_u32 m0, m0, 1024
    s_add_u32 s12, s12, s15
    buffer_load_dwordx4 v17, s[48:51], s12 offen lds
    s_add_u32 m0, m0, 1024
    s_add_u32 s12, s12, s15
    buffer_load_dwordx4 v17, s[48:51], s12 offen lds
    s_add_u32 s14, s14, 1
    s_add_u32 s73, s73, 32768
    s_and_b32 s73, s73, 131071
    s_waitcnt vmcnt(16) lgkmcnt(0)
    s_barrier
    s_bitcmp1_b32 s3, 0
    s_cbranch_scc1 KF_XV_10
    v_mfma_f32_16x16x32_bf16 v[40:43], v[28:31], v[24:27], v[40:43]
    v_mfma_f32_16x16x32_bf16 v[40:43], v[36:39], v[32:35], v[40:43]
    s_branch KF_XD_11
KF_XV_10:
    v_mfma_f32_16x16x32_bf16 v[40:43], v[24:27], v[28:31], v[40:43]
    v_mfma_f32_16x16x32_bf16 v[40:43], v[32:35], v[36:39], v[40:43]
KF_XD_11:
    s_add_u32 s10, s14, s75
    s_and_b32 s10, s10, 3
    s_and_b32 s11, s14, 12
    s_or_b32 s10, s10, s11
    s_lshl_b32 s11, s10, 7
    s_add_u32 s11, s11, s68
    s_add_u32 m0, s65, s73
    s_lshl_b32 s12, s10, 6
    buffer_load_dwordx4 v10, s[44:47], s11 offen lds
    s_add_u32 m0, m0, 4096
    s_add_u32 s11, s11, 65536
    buffer_load_dwordx4 v10, s[44:47], s11 offen lds
    s_add_u32 m0, m0, 4096
    s_add_u32 s11, s11, 65536
    buffer_load_dwordx4 v10, s[44:47], s11 offen lds
    s_add_u32 m0, m0, 4096
    s_add_u32 s11, s11, 65536
    buffer_load_dwordx4 v10, s[44:47], s11 offen lds
    s_mul_i32 s12, s12, 6144
    s_mov_b32 s15, 24576
    s_add_u32 m0, s66, s73
    s_add_u32 s12, s12, s71
    buffer_load_dwordx4 v16, s[48:51], s12 offen lds
    s_add_u32 m0, m0, 1024
    s_add_u32 s12, s12, s15
    buffer_load_dwordx4 v16, s[48:51], s12 offen lds
    s_add_u32 m0, m0, 1024
    s_add_u32 s12, s12, s15
    buffer_load_dwordx4 v17, s[48:51], s12 offen lds
    s_add_u32 m0, m0, 1024
    s_add_u32 s12, s12, s15
    buffer_load_dwordx4 v17, s[48:51], s12 offen lds
    s_add_u32 s14, s14, 1
    s_add_u32 s73, s73, 32768
    s_and_b32 s73, s73, 131071
    s_lshl_b32 s10, s6, 2
    s_lshr_b32 s11, s3, 1
    s_add_u32 s10, s10, s11
    s_lshl_b32 s10, s10, 12
    s_add_u32 s10, s10, 8388608
    v_and_b32 v19, 1, v3
    v_lshl_add_u32 v19, v19, 5, v18
    v_lshlrev_b32 v19, 4, v19
    v_lshrrev_b32 v20, 1, v3
    v_lshl_add_u32 v19, v20, 3, v19
    s_and_b32 s11, s13, 1
    s_lshr_b32 s12, s13, 1
    s_lshl_b32 s15, s11, 8
    s_lshl_b32 s72, s12, 10
    s_add_u32 s15, s15, s72
    s_lshl_b32 s11, s11, 10
    s_lshl_b32 s12, s12, 8
    s_add_u32 s11, s11, s12
    s_add_u32 s11, s11, 2048
    s_mov_b32 s12, 0x3e8293ee
    s_bitcmp1_b32 s3, 0
    s_cselect_b32 s15, s11, s15
    s_cselect_b32 s12, 1.0, s12
    s_add_u32 s10, s10, s15
    v_mul_f32 v40, s12, v40
    v_mul_f32 v41, s12, v41
    v_mul_f32 v42, s12, v42
    v_mul_f32 v43, s12, v43
    v_cvt_pk_bf16_f32 v40, v40, v41
    v_cvt_pk_bf16_f32 v41, v42, v43
    s_waitcnt vmcnt(16)
    buffer_store_dwordx2 v[40:41], v19, s[52:55], s10 offen sc0 sc1
    s_mov_b32 s67, 12
    s_branch KF_L2
KF_LB:
    s_add_u32 s10, s14, s75
    s_and_b32 s10, s10, 3
    s_and_b32 s11, s14, 12
    s_or_b32 s10, s10, s11
    s_lshl_b32 s11, s10, 7
    s_add_u32 s11, s11, s68
    s_add_u32 m0, s65, s73
    s_lshl_b32 s12, s10, 6
    buffer_load_dwordx4 v10, s[36:39], s11 offen lds
    s_add_u32 m0, m0, 4096
    s_add_u32 s11, s11, 65536
    buffer_load_dwordx4 v10, s[36:39], s11 offen lds
    s_add_u32 m0, m0, 4096
    s_add_u32 s11, s11, 65536
    buffer_load_dwordx4 v10, s[36:39], s11 offen lds
    s_add_u32 m0, m0, 4096
    s_add_u32 s11, s11, 65536
    buffer_load_dwordx4 v10, s[36:39], s11 offen lds
    s_mul_i32 s12, s12, s64
    s_lshl_b32 s15, s64, 2
    s_add_u32 m0, s66, s73
    s_add_u32 s12, s12, s70
    buffer_load_dwordx4 v11, s[40:43], s12 offen lds
    s_add_u32 m0, m0, 1024
    s_add_u32 s12, s12, s15
    buffer_load_dwordx4 v11, s[40:43], s12 offen lds
    s_add_u32 m0, m0, 1024
    s_add_u32 s12, s12, s15
    buffer_load_dwordx4 v12, s[40:43], s12 offen lds
    s_add_u32 m0, m0, 1024
    s_add_u32 s12, s12, s15
    buffer_load_dwordx4 v12, s[40:43], s12 offen lds
    s_add_u32 s14, s14, 1
    s_add_u32 s73, s73, 32768
    s_and_b32 s73, s73, 131071
    s_add_u32 s10, s14, s75
    s_and_b32 s10, s10, 3
    s_and_b32 s11, s14, 12
    s_or_b32 s10, s10, s11
    s_lshl_b32 s11, s10, 7
    s_add_u32 s11, s11, s68
    s_add_u32 m0, s65, s73
    s_lshl_b32 s12, s10, 6
    buffer_load_dwordx4 v10, s[36:39], s11 offen lds
    s_add_u32 m0, m0, 4096
    s_add_u32 s11, s11, 65536
    buffer_load_dwordx4 v10, s[36:39], s11 offen lds
    s_add_u32 m0, m0, 4096
    s_add_u32 s11, s11, 65536
    buffer_load_dwordx4 v10, s[36:39], s11 offen lds
    s_add_u32 m0, m0, 4096
    s_add_u32 s11, s11, 65536
    buffer_load_dwordx4 v10, s[36:39], s11 offen lds
    s_mul_i32 s12, s12, s64
    s_lshl_b32 s15, s64, 2
    s_add_u32 m0, s66, s73
    s_add_u32 s12, s12, s70
    buffer_load_dwordx4 v11, s[40:43], s12 offen lds
    s_add_u32 m0, m0, 1024
    s_add_u32 s12, s12, s15
    buffer_load_dwordx4 v11, s[40:43], s12 offen lds
    s_add_u32 m0, m0, 1024
    s_add_u32 s12, s12, s15
    buffer_load_dwordx4 v12, s[40:43], s12 offen lds
    s_add_u32 m0, m0, 1024
    s_add_u32 s12, s12, s15
    buffer_load_dwordx4 v12, s[40:43], s12 offen lds
    s_add_u32 s14, s14, 1
    s_add_u32 s73, s73, 32768
    s_and_b32 s73, s73, 131071
    v_mul_u32_u24 v7, 6144, v3
    v_add_u32 v16, v6, v7
    v_xor_b32 v17, 128, v16
    v_and_b32 v44, 7, v0
    s_lshl_b32 s10, s5, 5
    v_add_u32 v44, s10, v44
    v_lshlrev_b32 v44, 2, v44
    s_mov_b32 s69, s13
    s_mov_b32 s44, s26
    s_and_b32 s45, s27, 0xffff
    s_mov_b32 s46, 4194304
    s_mov_b32 s47, 0x20000
    s_mov_b32 s48, s28
    s_and_b32 s49, s29, 0xffff
    s_mov_b32 s50, 6291456
    s_mov_b32 s51, 0x20000
    s_mov_b32 s52, s32
    s_and_b32 s53, s33, 0xffff
    s_mov_b32 s54, 21004288
    s_mov_b32 s55, 0x20000
    s_and_b32 s25, s25, 0xffff
    s_mov_b32 s26, 0x200000
    s_mov_b32 s27, 0x20000
    s_mov_b32 s28, s34
    s_and_b32 s29, s35, 0xffff
    s_mov_b32 s30, 0x800000
    s_mov_b32 s31, 0x20000
    s_and_b32 s10, s8, 2
    s_lshr_b32 s11, s8, 2
    s_add_u32 s88, s10, s11
    s_and_b32 s89, s8, 1
    s_lshl_b32 s10, s88, 13
    s_lshl_b32 s11, s89, 12
    s_add_u32 s92, s10, s11
    s_lshl_b32 s12, s3, 2
    s_add_u32 s12, s12, s88
    s_lshl_b32 s13, s8, 10
    s_cmp_eq_u32 s5, 1
    s_cselect_b32 s93, 0, s10
    s_cselect_b32 s18, 32, s12
    s_cselect_b32 s16, s13, s92
    s_cselect_b32 s20, s13, s11
    s_cselect_b32 s23, 0, 64
    s_lshl_b32 s18, s18, 18
    s_add_u32 s18, s18, 0
    s_add_u32 s80, s32, s18
    s_addc_u32 s81, s33, 0
    s_and_b32 s81, s81, 0xffff
    s_mov_b32 s82, 0x40000
    s_mov_b32 s83, 0x20000
    s_add_u32 s20, s20, 24576
    s_and_b32 s21, s3, 4
    s_lshl_b32 s21, s21, 15
    s_add_u32 s84, s16, 98304
    s_mov_b32 s85, s16
    s_add_u32 s86, s16, 32768
    s_add_u32 s87, s16, 65536
    s_lshl_b32 s13, s6, 2
    s_add_u32 s23, s23, s13
    s_lshl_b32 s94, s23, 16
    s_lshl_b32 s13, s89, 1
    s_add_u32 s23, s23, s13
    s_lshl_b32 s23, s23, 6
    s_lshl_b32 s12, s12, 1
    s_add_u32 s23, s23, s12
    s_lshl_b32 s23, s23, 10
    s_add_u32 s23, s23, 12582912
    s_lshl_b32 s10, s5, 4
    s_add_u32 s10, s10, s6
    s_lshl_b32 s95, s10, 10
    s_add_u32 s95, s95, 20971520
    s_mov_b32 s91, 0x71800000
    s_mov_b32 s13, s69
    s_cmp_lg_u32 s13, 0
    s_cbranch_scc1 KF_NCLR_12
    s_lshl_b32 s10, s3, 7
    s_add_u32 s10, s10, s95
    v_mov_b32 v45, 0
    v_lshlrev_b32 v46, 2, v0
    s_mov_b64 exec, 0xff
    buffer_store_dword v45, v46, s[52:55], s10 offen sc0 sc1
    s_mov_b64 exec, -1
KF_NCLR_12:
    s_waitcnt vmcnt(8)
    s_barrier
    s_add_u32 s10, s14, s75
    s_and_b32 s10, s10, 3
    s_and_b32 s11, s14, 12
    s_or_b32 s10, s10, s11
    s_lshl_b32 s11, s10, 7
    s_add_u32 s11, s11, s68
    s_add_u32 m0, s65, s73
    s_lshl_b32 s12, s10, 6
    buffer_load_dwordx4 v10, s[36:39], s11 offen lds
    s_add_u32 m0, m0, 4096
    s_add_u32 s11, s11, 65536
    buffer_load_dwordx4 v10, s[36:39], s11 offen lds
    s_add_u32 m0, m0, 4096
    s_add_u32 s11, s11, 65536
    buffer_load_dwordx4 v10, s[36:39], s11 offen lds
    s_add_u32 m0, m0, 4096
    s_add_u32 s11, s11, 65536
    buffer_load_dwordx4 v10, s[36:39], s11 offen lds
    s_mul_i32 s12, s12, s64
    s_lshl_b32 s15, s64, 2
    s_add_u32 m0, s66, s73
    s_add_u32 s12, s12, s70
    buffer_load_dwordx4 v11, s[40:43], s12 offen lds
    s_add_u32 m0, m0, 1024
    s_add_u32 s12, s12, s15
    buffer_load_dwordx4 v11, s[40:43], s12 offen lds
    s_add_u32 m0, m0, 1024
    s_add_u32 s12, s12, s15
    buffer_load_dwordx4 v12, s[40:43], s12 offen lds
    s_add_u32 m0, m0, 1024
    s_add_u32 s12, s12, s15
    buffer_load_dwordx4 v12, s[40:43], s12 offen lds
    s_add_u32 s14, s14, 1
    s_add_u32 s73, s73, 32768
    s_and_b32 s73, s73, 131071
    s_add_u32 s10, s14, s75
    s_and_b32 s10, s10, 3
    s_and_b32 s11, s14, 12
    s_or_b32 s10, s10, s11
    s_lshl_b32 s11, s10, 7
    s_add_u32 s11, s11, s68
    s_add_u32 m0, s65, s73
    s_lshl_b32 s12, s10, 6
    buffer_load_dwordx4 v10, s[36:39], s11 offen lds
    s_add_u32 m0, m0, 4096
    s_add_u32 s11, s11, 65536
    buffer_load_dwordx4 v10, s[36:39], s11 offen lds
    s_add_u32 m0, m0, 4096
    s_add_u32 s11, s11, 65536
    buffer_load_dwordx4 v10, s[36:39], s11 offen lds
    s_add_u32 m0, m0, 4096
    s_add_u32 s11, s11, 65536
    buffer_load_dwordx4 v10, s[36:39], s11 offen lds
    s_mul_i32 s12, s12, s64
    s_lshl_b32 s15, s64, 2
    s_add_u32 m0, s66, s73
    s_add_u32 s12, s12, s70
    buffer_load_dwordx4 v11, s[40:43], s12 offen lds
    s_add_u32 m0, m0, 1024
    s_add_u32 s12, s12, s15
    buffer_load_dwordx4 v11, s[40:43], s12 offen lds
    s_add_u32 m0, m0, 1024
    s_add_u32 s12, s12, s15
    buffer_load_dwordx4 v12, s[40:43], s12 offen lds
    s_add_u32 m0, m0, 1024
    s_add_u32 s12, s12, s15
    buffer_load_dwordx4 v12, s[40:43], s12 offen lds
    s_add_u32 s14, s14, 1
    s_add_u32 s73, s73, 32768
    s_and_b32 s73, s73, 131071
    s_waitcnt vmcnt(16) lgkmcnt(0)
    s_mov_b32 s67, 12
KF_L10:
    s_barrier
    s_add_u32 s10, s14, s75
    s_and_b32 s10, s10, 3
    s_and_b32 s11, s14, 12
    s_or_b32 s10, s10, s11
    s_lshl_b32 s11, s10, 7
    s_add_u32 s11, s11, s68
    s_add_u32 m0, s65, s73
    s_lshl_b32 s12, s10, 6
    buffer_load_dwordx4 v10, s[36:39], s11 offen lds
    s_add_u32 m0, m0, 4096
    s_add_u32 s11, s11, 65536
    buffer_load_dwordx4 v10, s[36:39], s11 offen lds
    s_add_u32 m0, m0, 4096
    s_add_u32 s11, s11, 65536
    buffer_load_dwordx4 v10, s[36:39], s11 offen lds
    s_add_u32 m0, m0, 4096
    s_add_u32 s11, s11, 65536
    buffer_load_dwordx4 v10, s[36:39], s11 offen lds
    s_mul_i32 s12, s12, s64
    s_lshl_b32 s15, s64, 2
    s_add_u32 m0, s66, s73
    s_add_u32 s12, s12, s70
    buffer_load_dwordx4 v11, s[40:43], s12 offen lds
    s_add_u32 m0, m0, 1024
    s_add_u32 s12, s12, s15
    buffer_load_dwordx4 v11, s[40:43], s12 offen lds
    s_add_u32 m0, m0, 1024
    s_add_u32 s12, s12, s15
    buffer_load_dwordx4 v12, s[40:43], s12 offen lds
    s_add_u32 m0, m0, 1024
    s_add_u32 s12, s12, s15
    buffer_load_dwordx4 v12, s[40:43], s12 offen lds
    s_add_u32 s14, s14, 1
    s_add_u32 s73, s73, 32768
    s_and_b32 s73, s73, 131071
    s_sub_u32 s67, s67, 1
    s_cmp_lg_u32 s67, 0
    s_waitcnt vmcnt(16) lgkmcnt(0)
    s_cbranch_scc1 KF_L10
    s_mov_b32 s14, 0
    s_mov_b32 s67, 16
KF_L2:
    s_barrier
    s_cmp_lg_u32 s67, 8
    s_cbranch_scc1 KF_L2N
    s_cmp_lg_u32 s13, 0
    s_cbranch_scc1 KF_L2N
    s_add_u32 s10, s3, 32
    s_cmp_eq_u32 s5, 1
    s_cselect_b32 s10, s10, s7
    s_lshl_b32 s10, s10, 2
    v_mov_b32 v18, 1
    v_mov_b32 v19, s10
    s_mov_b64 exec, 1
    buffer_atomic_add v18, v19, s[60:63], 0 offen sc1
    s_mov_b64 exec, -1
KF_L2N:
    s_cmp_lg_u32 s67, 2
    s_cbranch_scc1 KF_L2M
    buffer_load_dword v45, v44, s[60:63], 0 offen sc0 sc1
KF_L2M:
    s_add_u32 s10, s14, s75
    s_and_b32 s10, s10, 3
    s_and_b32 s11, s14, 12
    s_or_b32 s10, s10, s11
    s_lshl_b32 s11, s10, 7
    s_add_u32 s11, s11, s68
    s_add_u32 m0, s65, s73
    s_lshl_b32 s12, s10, 6
    buffer_load_dwordx4 v10, s[44:47], s11 offen lds
    s_add_u32 m0, m0, 4096
    s_add_u32 s11, s11, 65536
    buffer_load_dwordx4 v10, s[44:47], s11 offen lds
    s_add_u32 m0, m0, 4096
    s_add_u32 s11, s11, 65536
    buffer_load_dwordx4 v10, s[44:47], s11 offen lds
    s_add_u32 m0, m0, 4096
    s_add_u32 s11, s11, 65536
    buffer_load_dwordx4 v10, s[44:47], s11 offen lds
    s_mul_i32 s12, s12, 6144
    s_mov_b32 s15, 24576
    s_add_u32 m0, s66, s73
    s_add_u32 s12, s12, s71
    buffer_load_dwordx4 v16, s[48:51], s12 offen lds
    s_add_u32 m0, m0, 1024
    s_add_u32 s12, s12, s15
    buffer_load_dwordx4 v16, s[48:51], s12 offen lds
    s_add_u32 m0, m0, 1024
    s_add_u32 s12, s12, s15
    buffer_load_dwordx4 v17, s[48:51], s12 offen lds
    s_add_u32 m0, m0, 1024
    s_add_u32 s12, s12, s15
    buffer_load_dwordx4 v17, s[48:51], s12 offen lds
    s_add_u32 s14, s14, 1
    s_add_u32 s73, s73, 32768
    s_and_b32 s73, s73, 131071
    s_sub_u32 s67, s67, 1
    s_cmp_lg_u32 s67, 0
    s_waitcnt vmcnt(16)
    s_cbranch_scc1 KF_L2
    v_cmp_gt_u32 vcc, 16, v45
    s_mov_b32 s67, 0
    s_nop 1
    s_cbranch_vccz KF_P1D
KF_P1:
    buffer_load_dword v45, v44, s[60:63], 0 offen sc0 sc1
    s_add_u32 s67, s67, 1
    s_waitcnt vmcnt(0)
    v_cmp_gt_u32 vcc, 16, v45
    s_cmp_gt_u32 s67, 0x40000
    s_cbranch_scc1 KF_P1D
    s_cbranch_vccnz KF_P1
KF_P1D:
    s_lshl_b32 s10, s3, 20
    s_cmp_eq_u32 s5, 1
    s_cselect_b32 s10, 8388608, s10
    s_add_u32 s10, s10, 0
    s_add_u32 s36, s32, s10
    s_addc_u32 s37, s33, 0
    s_and_b32 s37, s37, 0xffff
    s_mov_b32 s38, 0x100000
    s_cmp_eq_u32 s5, 1
    s_cbranch_scc1 KF_IA
    s_lshl_b32 s11, s13, 18
    s_add_u32 s11, s11, s21
    s_lshl_b32 s12, s13, 13
    s_barrier
    s_add_u32 m0, s12, 0
    s_add_u32 s10, s11, 0
    buffer_load_dwordx4 v1, s[36:39], s10 offen offset:0 sc1 lds
    buffer_load_dwordx4 v1, s[36:39], s10 offen offset:1024 sc1 lds
    buffer_load_dwordx4 v1, s[36:39], s10 offen offset:2048 sc1 lds
    buffer_load_dwordx4 v1, s[36:39], s10 offen offset:3072 sc1 lds
    s_add_u32 m0, s12, 4096
    s_add_u32 s10, s11, 4096
    buffer_load_dwordx4 v1, s[36:39], s10 offen offset:0 sc1 lds
    buffer_load_dwordx4 v1, s[36:39], s10 offen offset:1024 sc1 lds
    buffer_load_dwordx4 v1, s[36:39], s10 offen offset:2048 sc1 lds
    buffer_load_dwordx4 v1, s[36:39], s10 offen offset:3072 sc1 lds
    s_waitcnt vmcnt(16)
    s_barrier
    s_add_u32 m0, s12, 32768
    s_add_u32 s10, s11, 8192
    buffer_load_dwordx4 v1, s[36:39], s10 offen offset:0 sc1 lds
    buffer_load_dwordx4 v1, s[36:39], s10 offen offset:1024 sc1 lds
    buffer_load_dwordx4 v1, s[36:39], s10 offen offset:2048 sc1 lds
    buffer_load_dwordx4 v1, s[36:39], s10 offen offset:3072 sc1 lds
    s_add_u32 m0, s12, 36864
    s_add_u32 s10, s11, 12288
    buffer_load_dwordx4 v1, s[36:39], s10 offen offset:0 sc1 lds
    buffer_load_dwordx4 v1, s[36:39], s10 offen offset:1024 sc1 lds
    buffer_load_dwordx4 v1, s[36:39], s10 offen offset:2048 sc1 lds
    buffer_load_dwordx4 v1, s[36:39], s10 offen offset:3072 sc1 lds
    s_waitcnt vmcnt(16)
    s_barrier
    s_add_u32 m0, s12, 65536
    s_add_u32 s10, s11, 16384
    buffer_load_dwordx4 v1, s[36:39], s10 offen offset:0 sc1 lds
    buffer_load_dwordx4 v1, s[36:39], s10 offen offset:1024 sc1 lds
    buffer_load_dwordx4 v1, s[36:39], s10 offen offset:2048 sc1 lds
    buffer_load_dwordx4 v1, s[36:39], s10 offen offset:3072 sc1 lds
    s_add_u32 m0, s12, 69632
    s_add_u32 s10, s11, 20480
    buffer_load_dwordx4 v1, s[36:39], s10 offen offset:0 sc1 lds
    buffer_load_dwordx4 v1, s[36:39], s10 offen offset:1024 sc1 lds
    buffer_load_dwordx4 v1, s[36:39], s10 offen offset:2048 sc1 lds
    buffer_load_dwordx4 v1, s[36:39], s10 offen offset:3072 sc1 lds
    s_waitcnt vmcnt(16)
    s_branch KF_ID
KF_IA:
    s_lshl_b32 s12, s13, 11
    s_barrier
    s_add_u32 m0, s12, 0
    s_add_u32 s10, s12, 0
    buffer_load_dwordx4 v1, s[36:39], s10 offen offset:0 sc1 lds
    buffer_load_dwordx4 v1, s[36:39], s10 offen offset:1024 sc1 lds
    s_waitcnt vmcnt(10)
    s_barrier
    s_add_u32 m0, s12, 32768
    s_add_u32 s10, s12, 8192
    buffer_load_dwordx4 v1, s[36:39], s10 offen offset:0 sc1 lds
    buffer_load_dwordx4 v1, s[36:39], s10 offen offset:1024 sc1 lds
    s_waitcnt vmcnt(4)
    s_barrier
    s_add_u32 m0, s12, 65536
    s_add_u32 s10, s12, 16384
    buffer_load_dwordx4 v1, s[36:39], s10 offen offset:0 sc1 lds
    buffer_load_dwordx4 v1, s[36:39], s10 offen offset:1024 sc1 lds
    s_waitcnt vmcnt(4)
KF_ID:
    s_setprio 0
    v_mov_b32 v14, 0
    v_add_u32 v249, s93, v1
    v_add_u32 v254, 65536, v249
    v_and_b32 v5, 2, v0
    v_lshrrev_b32 v6, 2, v0
    v_and_b32 v6, 1, v6
    v_or_b32 v4, v5, v6
    v_xor_b32 v6, 1, v6
    v_or_b32 v6, v5, v6
    v_mov_b32 v5, 0x3f803f80
    v_cmp_eq_u32 vcc, 0, v4
    v_cmp_eq_u32 s[10:11], 0, v6
    v_and_b32 v4, 1, v0
    v_cndmask_b32 v60, 0, v5, vcc
    v_cndmask_b32 v62, 0, v5, s[10:11]
    v_cmp_eq_u32 vcc, 0, v4
    v_mov_b32 v61, v60
    v_mov_b32 v63, v62
    v_mov_b32 v5, 0x4444
    v_mov_b32 v6, 0xeeee
    v_cndmask_b32 v248, v6, v5, vcc
    v_mov_b32 v20, 0
    v_mov_b32 v21, 0
    v_mov_b32 v22, 0
    v_mov_b32 v23, 0
    v_mov_b32 v24, 0
    v_mov_b32 v25, 0
    v_mov_b32 v26, 0
    v_mov_b32 v27, 0
    v_mov_b32 v28, 0
    v_mov_b32 v29, 0
    v_mov_b32 v30, 0
    v_mov_b32 v31, 0
    v_mov_b32 v32, 0
    v_mov_b32 v33, 0
    v_mov_b32 v34, 0
    v_mov_b32 v35, 0
    v_mov_b32 v36, 0
    v_mov_b32 v37, 0
    v_mov_b32 v38, 0
    v_mov_b32 v39, 0
    v_mov_b32 v40, 0
    v_mov_b32 v41, 0
    v_mov_b32 v42, 0
    v_mov_b32 v43, 0
    v_mov_b32 v44, 0
    v_mov_b32 v45, 0
    v_mov_b32 v46, 0
    v_mov_b32 v47, 0
    v_mov_b32 v48, 0
    v_mov_b32 v49, 0
    v_mov_b32 v50, 0
    v_mov_b32 v51, 0
    v_mov_b32 v52, 0
    v_mov_b32 v53, 0
    v_mov_b32 v54, 0
    v_mov_b32 v55, 0
    v_mov_b32 v56, 0
    v_mov_b32 v57, 0
    v_mov_b32 v58, 0
    v_mov_b32 v59, 0
    v_mov_b32 v224, 0
    v_mov_b32 v225, 0
    v_mov_b32 v226, 0
    v_mov_b32 v227, 0
    v_mov_b32 v228, 0
    v_mov_b32 v229, 0
    v_mov_b32 v230, 0
    v_mov_b32 v231, 0
    v_mov_b32 v240, 0
    v_mov_b32 v241, 0
    v_mov_b32 v242, 0
    v_mov_b32 v243, 0
    v_mov_b32 v244, 0
    v_mov_b32 v245, 0
    v_mov_b32 v246, 0
    v_mov_b32 v247, 0
    s_barrier
    s_branch KF_ATT
KF_COMP:
    s_mov_b64 s[34:35], s[56:57]
    v_and_b32 v2, 15, v0
    v_lshrrev_b32 v3, 4, v0
    v_lshrrev_b32 v4, 1, v2
    v_xor_b32 v4, v4, v3
    v_lshlrev_b32 v5, 7, v2
    v_lshl_add_u32 v4, v4, 4, v5
    s_and_b32 s10, s8, 1
    s_lshl_b32 s10, s10, 13
    v_add_u32 v8, s10, v4
    v_xor_b32 v9, 64, v8
    v_lshrrev_b32 v2, 2, v2
    v_and_b32 v4, 1, v3
    v_lshl_add_u32 v4, v4, 2, v2
    s_and_b32 s10, s8, 2
    s_lshl_b32 s10, s10, 1
    v_xor_b32 v4, s10, v4
    v_lshlrev_b32 v4, 5, v4
    v_lshl_add_u32 v5, v3, 3, v2
    v_lshl_add_u32 v4, v5, 8, v4
    v_and_b32 v5, 3, v0
    v_lshl_add_u32 v4, v5, 3, v4
    v_add_u32 v10, 16384, v4
    v_xor_b32 v11, 32, v10
    v_xor_b32 v12, 64, v10
    v_xor_b32 v13, 96, v10
    v_add_u32 v14, 65536, v8
    v_add_u32 v15, 65536, v9
    v_add_u32 v16, 65536, v10
    v_add_u32 v17, 65536, v11
    v_add_u32 v18, 65536, v12
    v_add_u32 v19, 65536, v13
    v_and_b32 v2, 1, v3
    v_lshrrev_b32 v4, 5, v0
    v_lshl_add_u32 v2, v2, 1, v4
    v_and_b32 v4, 15, v0
    v_lshl_add_u32 v2, v2, 4, v4
    v_lshlrev_b32 v7, 4, v2
    s_lshl_b32 s10, s7, 2
    s_and_b32 s11, s8, 2
    s_add_u32 s10, s10, s11
    s_lshl_b32 s10, s10, 18
    s_lshl_b32 s11, s6, 2
    s_and_b32 s13, s8, 1
    s_lshl_b32 s13, s13, 1
    s_add_u32 s11, s11, s13
    s_lshl_b32 s11, s11, 12
    s_add_u32 s10, s10, s11
    s_sub_u32 s11, s9, 1
    s_lshl_b32 s11, s11, 11
    s_add_u32 s10, s10, s11
    s_add_u32 s72, s10, 0
    s_mov_b32 s58, 0x3e8293ee
    s_mov_b32 s59, 0x3e8293ee
    s_mov_b32 s14, 0
    s_and_b32 s10, s8, 2
    s_lshl_b32 s10, s10, 13
    s_and_b32 s11, s8, 1
    s_lshl_b32 s11, s11, 12
    s_add_u32 s10, s10, s11
    s_add_u32 s10, s10, 98304
    v_add_u32 v2, s10, v7
    s_mov_b32 s44, s26
    s_and_b32 s45, s27, 0xffff
    s_mov_b32 s46, 4194304
    s_mov_b32 s47, 0x20000
    s_mov_b32 s48, s28
    s_and_b32 s49, s29, 0xffff
    s_mov_b32 s50, 6291456
    s_mov_b32 s51, 0x20000
    s_mov_b32 s52, s32
    s_and_b32 s53, s33, 0xffff
    s_mov_b32 s54, 21004288
    s_mov_b32 s55, 0x20000
    s_and_b32 s25, s25, 0xffff
    s_mov_b32 s26, 0x200000
    s_mov_b32 s27, 0x20000
    s_mov_b32 s28, s34
    s_and_b32 s29, s35, 0xffff
    s_mov_b32 s30, 0x800000
    s_mov_b32 s31, 0x20000
    s_and_b32 s10, s8, 2
    s_lshr_b32 s11, s8, 2
    s_add_u32 s88, s10, s11
    s_and_b32 s89, s8, 1
    s_lshl_b32 s10, s88, 13
    s_lshl_b32 s11, s89, 12
    s_add_u32 s92, s10, s11
    s_lshl_b32 s12, s3, 2
    s_add_u32 s12, s12, s88
    s_lshl_b32 s13, s8, 10
    s_cmp_eq_u32 s5, 1
    s_cselect_b32 s93, 0, s10
    s_cselect_b32 s18, 32, s12
    s_cselect_b32 s16, s13, s92
    s_cselect_b32 s20, s13, s11
    s_cselect_b32 s23, 0, 64
    s_lshl_b32 s18, s18, 18
    s_add_u32 s18, s18, 0
    s_add_u32 s80, s32, s18
    s_addc_u32 s81, s33, 0
    s_and_b32 s81, s81, 0xffff
    s_mov_b32 s82, 0x40000
    s_mov_b32 s83, 0x20000
    s_add_u32 s20, s20, 24576
    s_and_b32 s21, s3, 4
    s_lshl_b32 s21, s21, 15
    s_add_u32 s84, s16, 98304
    s_mov_b32 s85, s16
    s_add_u32 s86, s16, 32768
    s_add_u32 s87, s16, 65536
    s_lshl_b32 s13, s6, 2
    s_add_u32 s23, s23, s13
    s_lshl_b32 s94, s23, 16
    s_lshl_b32 s13, s89, 1
    s_add_u32 s23, s23, s13
    s_lshl_b32 s23, s23, 6
    s_lshl_b32 s12, s12, 1
    s_add_u32 s23, s23, s12
    s_lshl_b32 s23, s23, 10
    s_add_u32 s23, s23, 12582912
    s_lshl_b32 s10, s5, 4
    s_add_u32 s10, s10, s6
    s_lshl_b32 s95, s10, 10
    s_add_u32 s95, s95, 20971520
    s_mov_b32 s91, 0x71800000
    v_add_u32 v249, s93, v1
    v_add_u32 v254, 65536, v249
    v_and_b32 v5, 2, v0
    v_lshrrev_b32 v6, 2, v0
    v_and_b32 v6, 1, v6
    v_or_b32 v4, v5, v6
    v_xor_b32 v6, 1, v6
    v_or_b32 v6, v5, v6
    v_mov_b32 v5, 0x3f803f80
    v_cmp_eq_u32 vcc, 0, v4
    v_cmp_eq_u32 s[10:11], 0, v6
    v_and_b32 v4, 1, v0
    v_cndmask_b32 v60, 0, v5, vcc
    v_cndmask_b32 v62, 0, v5, s[10:11]
    v_cmp_eq_u32 vcc, 0, v4
    v_mov_b32 v61, v60
    v_mov_b32 v63, v62
    v_mov_b32 v5, 0x4444
    v_mov_b32 v6, 0xeeee
    v_cndmask_b32 v248, v6, v5, vcc
    v_mov_b32 v20, 0
    v_mov_b32 v21, 0
    v_mov_b32 v22, 0
    v_mov_b32 v23, 0
    v_mov_b32 v24, 0
    v_mov_b32 v25, 0
    v_mov_b32 v26, 0
    v_mov_b32 v27, 0
    v_mov_b32 v28, 0
    v_mov_b32 v29, 0
    v_mov_b32 v30, 0
    v_mov_b32 v31, 0
    v_mov_b32 v32, 0
    v_mov_b32 v33, 0
    v_mov_b32 v34, 0
    v_mov_b32 v35, 0
    v_mov_b32 v36, 0
    v_mov_b32 v37, 0
    v_mov_b32 v38, 0
    v_mov_b32 v39, 0
    v_mov_b32 v40, 0
    v_mov_b32 v41, 0
    v_mov_b32 v42, 0
    v_mov_b32 v43, 0
    v_mov_b32 v44, 0
    v_mov_b32 v45, 0
    v_mov_b32 v46, 0
    v_mov_b32 v47, 0
    v_mov_b32 v48, 0
    v_mov_b32 v49, 0
    v_mov_b32 v50, 0
    v_mov_b32 v51, 0
    v_mov_b32 v52, 0
    v_mov_b32 v53, 0
    v_mov_b32 v54, 0
    v_mov_b32 v55, 0
    v_mov_b32 v56, 0
    v_mov_b32 v57, 0
    v_mov_b32 v58, 0
    v_mov_b32 v59, 0
    v_mov_b32 v224, 0
    v_mov_b32 v225, 0
    v_mov_b32 v226, 0
    v_mov_b32 v227, 0
    v_mov_b32 v228, 0
    v_mov_b32 v229, 0
    v_mov_b32 v230, 0
    v_mov_b32 v231, 0
    v_mov_b32 v240, 0
    v_mov_b32 v241, 0
    v_mov_b32 v242, 0
    v_mov_b32 v243, 0
    v_mov_b32 v244, 0
    v_mov_b32 v245, 0
    v_mov_b32 v246, 0
    v_mov_b32 v247, 0
KF_CS:
    s_mov_b32 s10, 4
    s_cmp_eq_u32 s15, 2
    s_cbranch_scc1 KF_CV
    s_barrier
    ds_read_b64_tr_b16 v[80:81], v10 offset:0
    ds_read_b64_tr_b16 v[82:83], v10 offset:1024
    ds_read_b128 v[64:67], v8 offset:0
    ds_read_b64_tr_b16 v[84:85], v11 offset:0
    ds_read_b64_tr_b16 v[86:87], v11 offset:1024
    ds_read_b128 v[68:71], v8 offset:2048
    ds_read_b64_tr_b16 v[88:89], v12 offset:0
    ds_read_b64_tr_b16 v[90:91], v12 offset:1024
    ds_read_b128 v[72:75], v8 offset:4096
    ds_read_b64_tr_b16 v[92:93], v13 offset:0
    ds_read_b64_tr_b16 v[94:95], v13 offset:1024
    ds_read_b128 v[76:79], v8 offset:6144
    s_waitcnt lgkmcnt(9)
    v_mfma_f32_16x16x32_bf16 v[128:131], v[80:83], v[64:67], 0
    ds_read_b64_tr_b16 v[112:113], v10 offset:8192
    s_waitcnt lgkmcnt(7)
    v_mfma_f32_16x16x32_bf16 v[136:139], v[84:87], v[64:67], 0
    ds_read_b64_tr_b16 v[114:115], v10 offset:9216
    v_mfma_f32_16x16x32_bf16 v[132:135], v[80:83], v[68:71], 0
    ds_read_b128 v[96:99], v9 offset:0
    v_mfma_f32_16x16x32_bf16 v[140:143], v[84:87], v[68:71], 0
    ds_read_b64_tr_b16 v[116:117], v11 offset:8192
    s_waitcnt lgkmcnt(7)
    v_mfma_f32_16x16x32_bf16 v[144:147], v[88:91], v[64:67], 0
    ds_read_b64_tr_b16 v[118:119], v11 offset:9216
    v_mfma_f32_16x16x32_bf16 v[148:151], v[88:91], v[68:71], 0
    ds_read_b128 v[100:103], v9 offset:2048
    v_mfma_f32_16x16x32_bf16 v[160:163], v[80:83], v[72:75], 0
    ds_read_b64_tr_b16 v[120:121], v12 offset:8192
    v_mfma_f32_16x16x32_bf16 v[168:171], v[84:87], v[72:75], 0
    ds_read_b64_tr_b16 v[122:123], v12 offset:9216
    v_mfma_f32_16x16x32_bf16 v[176:179], v[88:91], v[72:75], 0
    ds_read_b128 v[104:107], v9 offset:4096
    s_waitcnt lgkmcnt(9)
    v_mfma_f32_16x16x32_bf16 v[152:155], v[92:95], v[64:67], 0
    ds_read_b64_tr_b16 v[124:125], v13 offset:8192
    v_mfma_f32_16x16x32_bf16 v[156:159], v[92:95], v[68:71], 0
    ds_read_b64_tr_b16 v[126:127], v13 offset:9216
    v_mfma_f32_16x16x32_bf16 v[184:187], v[92:95], v[72:75], 0
    ds_read_b128 v[108:111], v9 offset:6144
    v_mfma_f32_16x16x32_bf16 v[164:167], v[80:83], v[76:79], 0
    v_mfma_f32_16x16x32_bf16 v[172:175], v[84:87], v[76:79], 0
    v_mfma_f32_16x16x32_bf16 v[180:183], v[88:91], v[76:79], 0
    v_mfma_f32_16x16x32_bf16 v[188:191], v[92:95], v[76:79], 0
    s_branch KF_CL0_E
.p2align 6
KF_CL0:
    s_waitcnt lgkmcnt(9)
    v_mfma_f32_16x16x32_bf16 v[128:131], v[112:115], v[96:99], v[128:131]
    s_waitcnt lgkmcnt(6)
    v_mfma_f32_16x16x32_bf16 v[136:139], v[116:119], v[96:99], v[136:139]
    v_mfma_f32_16x16x32_bf16 v[132:135], v[112:115], v[100:103], v[132:135]
    v_mfma_f32_16x16x32_bf16 v[140:143], v[116:119], v[100:103], v[140:143]
    s_waitcnt lgkmcnt(0) vmcnt(0)
    s_barrier
    v_mfma_f32_16x16x32_bf16 v[144:147], v[120:123], v[96:99], v[144:147]
    ds_read_b64_tr_b16 v[80:81], v10 offset:0
    v_mfma_f32_16x16x32_bf16 v[148:151], v[120:123], v[100:103], v[148:151]
    ds_read_b64_tr_b16 v[82:83], v10 offset:1024
    v_mfma_f32_16x16x32_bf16 v[160:163], v[112:115], v[104:107], v[160:163]
    ds_read_b128 v[64:67], v8 offset:0
    v_mfma_f32_16x16x32_bf16 v[168:171], v[116:119], v[104:107], v[168:171]
    ds_read_b64_tr_b16 v[84:85], v11 offset:0
    v_mfma_f32_16x16x32_bf16 v[176:179], v[120:123], v[104:107], v[176:179]
    ds_read_b64_tr_b16 v[86:87], v11 offset:1024
    v_mfma_f32_16x16x32_bf16 v[152:155], v[124:127], v[96:99], v[152:155]
    ds_read_b128 v[68:71], v8 offset:2048
    v_mfma_f32_16x16x32_bf16 v[156:159], v[124:127], v[100:103], v[156:159]
    ds_read_b64_tr_b16 v[88:89], v12 offset:0
    v_mfma_f32_16x16x32_bf16 v[184:187], v[124:127], v[104:107], v[184:187]
    ds_read_b64_tr_b16 v[90:91], v12 offset:1024
    v_mfma_f32_16x16x32_bf16 v[164:167], v[112:115], v[108:111], v[164:167]
    ds_read_b128 v[72:75], v8 offset:4096
    v_mfma_f32_16x16x32_bf16 v[172:175], v[116:119], v[108:111], v[172:175]
    ds_read_b64_tr_b16 v[92:93], v13 offset:0
    v_mfma_f32_16x16x32_bf16 v[180:183], v[120:123], v[108:111], v[180:183]
    ds_read_b64_tr_b16 v[94:95], v13 offset:1024
    v_mfma_f32_16x16x32_bf16 v[188:191], v[124:127], v[108:111], v[188:191]
    ds_read_b128 v[76:79], v8 offset:6144
    s_waitcnt lgkmcnt(9)
    v_mfma_f32_16x16x32_bf16 v[128:131], v[80:83], v[64:67], v[128:131]
    ds_read_b64_tr_b16 v[112:113], v10 offset:8192
    s_waitcnt lgkmcnt(7)
    v_mfma_f32_16x16x32_bf16 v[136:139], v[84:87], v[64:67], v[136:139]
    ds_read_b64_tr_b16 v[114:115], v10 offset:9216
    v_mfma_f32_16x16x32_bf16 v[132:135], v[80:83], v[68:71], v[132:135]
    ds_read_b128 v[96:99], v9 offset:0
    v_mfma_f32_16x16x32_bf16 v[140:143], v[84:87], v[68:71], v[140:143]
    ds_read_b64_tr_b16 v[116:117], v11 offset:8192
    s_waitcnt lgkmcnt(7)
    v_mfma_f32_16x16x32_bf16 v[144:147], v[88:91], v[64:67], v[144:147]
    ds_read_b64_tr_b16 v[118:119], v11 offset:9216
    v_mfma_f32_16x16x32_bf16 v[148:151], v[88:91], v[68:71], v[148:151]
    ds_read_b128 v[100:103], v9 offset:2048
    v_mfma_f32_16x16x32_bf16 v[160:163], v[80:83], v[72:75], v[160:163]
    ds_read_b64_tr_b16 v[120:121], v12 offset:8192
    v_mfma_f32_16x16x32_bf16 v[168:171], v[84:87], v[72:75], v[168:171]
    ds_read_b64_tr_b16 v[122:123], v12 offset:9216
    v_mfma_f32_16x16x32_bf16 v[176:179], v[88:91], v[72:75], v[176:179]
    ds_read_b128 v[104:107], v9 offset:4096
    s_waitcnt lgkmcnt(9)
    v_mfma_f32_16x16x32_bf16 v[152:155], v[92:95], v[64:67], v[152:155]
    ds_read_b64_tr_b16 v[124:125], v13 offset:8192
    v_mfma_f32_16x16x32_bf16 v[156:159], v[92:95], v[68:71], v[156:159]
    ds_read_b64_tr_b16 v[126:127], v13 offset:9216
    v_mfma_f32_16x16x32_bf16 v[184:187], v[92:95], v[72:75], v[184:187]
    ds_read_b128 v[108:111], v9 offset:6144
    v_mfma_f32_16x16x32_bf16 v[164:167], v[80:83], v[76:79], v[164:167]
    v_mfma_f32_16x16x32_bf16 v[172:175], v[84:87], v[76:79], v[172:175]
    v_mfma_f32_16x16x32_bf16 v[180:183], v[88:91], v[76:79], v[180:183]
    v_mfma_f32_16x16x32_bf16 v[188:191], v[92:95], v[76:79], v[188:191]
KF_CL0_E:
    s_waitcnt lgkmcnt(9)
    v_mfma_f32_16x16x32_bf16 v[128:131], v[112:115], v[96:99], v[128:131]
    s_waitcnt lgkmcnt(6)
    v_mfma_f32_16x16x32_bf16 v[136:139], v[116:119], v[96:99], v[136:139]
    v_mfma_f32_16x16x32_bf16 v[132:135], v[112:115], v[100:103], v[132:135]
    v_mfma_f32_16x16x32_bf16 v[140:143], v[116:119], v[100:103], v[140:143]
    s_waitcnt lgkmcnt(0)
    s_barrier
    v_mfma_f32_16x16x32_bf16 v[144:147], v[120:123], v[96:99], v[144:147]
    ds_read_b64_tr_b16 v[80:81], v10 offset:32768
    v_mfma_f32_16x16x32_bf16 v[148:151], v[120:123], v[100:103], v[148:151]
    ds_read_b64_tr_b16 v[82:83], v10 offset:33792
    v_mfma_f32_16x16x32_bf16 v[160:163], v[112:115], v[104:107], v[160:163]
    ds_read_b128 v[64:67], v8 offset:32768
    v_mfma_f32_16x16x32_bf16 v[168:171], v[116:119], v[104:107], v[168:171]
    ds_read_b64_tr_b16 v[84:85], v11 offset:32768
    v_mfma_f32_16x16x32_bf16 v[176:179], v[120:123], v[104:107], v[176:179]
    ds_read_b64_tr_b16 v[86:87], v11 offset:33792
    v_mfma_f32_16x16x32_bf16 v[152:155], v[124:127], v[96:99], v[152:155]
    ds_read_b128 v[68:71], v8 offset:34816
    v_mfma_f32_16x16x32_bf16 v[156:159], v[124:127], v[100:103], v[156:159]
    ds_read_b64_tr_b16 v[88:89], v12 offset:32768
    v_mfma_f32_16x16x32_bf16 v[184:187], v[124:127], v[104:107], v[184:187]
    ds_read_b64_tr_b16 v[90:91], v12 offset:33792
    v_mfma_f32_16x16x32_bf16 v[164:167], v[112:115], v[108:111], v[164:167]
    ds_read_b128 v[72:75], v8 offset:36864
    v_mfma_f32_16x16x32_bf16 v[172:175], v[116:119], v[108:111], v[172:175]
    ds_read_b64_tr_b16 v[92:93], v13 offset:32768
    v_mfma_f32_16x16x32_bf16 v[180:183], v[120:123], v[108:111], v[180:183]
    ds_read_b64_tr_b16 v[94:95], v13 offset:33792
    v_mfma_f32_16x16x32_bf16 v[188:191], v[124:127], v[108:111], v[188:191]
    ds_read_b128 v[76:79], v8 offset:38912
    s_waitcnt lgkmcnt(9)
    v_mfma_f32_16x16x32_bf16 v[128:131], v[80:83], v[64:67], v[128:131]
    ds_read_b64_tr_b16 v[112:113], v10 offset:40960
    s_waitcnt lgkmcnt(7)
    v_mfma_f32_16x16x32_bf16 v[136:139], v[84:87], v[64:67], v[136:139]
    ds_read_b64_tr_b16 v[114:115], v10 offset:41984
    v_mfma_f32_16x16x32_bf16 v[132:135], v[80:83], v[68:71], v[132:135]
    ds_read_b128 v[96:99], v9 offset:32768
    v_mfma_f32_16x16x32_bf16 v[140:143], v[84:87], v[68:71], v[140:143]
    ds_read_b64_tr_b16 v[116:117], v11 offset:40960
    s_waitcnt lgkmcnt(7)
    v_mfma_f32_16x16x32_bf16 v[144:147], v[88:91], v[64:67], v[144:147]
    ds_read_b64_tr_b16 v[118:119], v11 offset:41984
    v_mfma_f32_16x16x32_bf16 v[148:151], v[88:91], v[68:71], v[148:151]
    ds_read_b128 v[100:103], v9 offset:34816
    v_mfma_f32_16x16x32_bf16 v[160:163], v[80:83], v[72:75], v[160:163]
    ds_read_b64_tr_b16 v[120:121], v12 offset:40960
    v_mfma_f32_16x16x32_bf16 v[168:171], v[84:87], v[72:75], v[168:171]
    ds_read_b64_tr_b16 v[122:123], v12 offset:41984
    v_mfma_f32_16x16x32_bf16 v[176:179], v[88:91], v[72:75], v[176:179]
    ds_read_b128 v[104:107], v9 offset:36864
    s_waitcnt lgkmcnt(9)
    v_mfma_f32_16x16x32_bf16 v[152:155], v[92:95], v[64:67], v[152:155]
    ds_read_b64_tr_b16 v[124:125], v13 offset:40960
    v_mfma_f32_16x16x32_bf16 v[156:159], v[92:95], v[68:71], v[156:159]
    ds_read_b64_tr_b16 v[126:127], v13 offset:41984
    v_mfma_f32_16x16x32_bf16 v[184:187], v[92:95], v[72:75], v[184:187]
    ds_read_b128 v[108:111], v9 offset:38912
    v_mfma_f32_16x16x32_bf16 v[164:167], v[80:83], v[76:79], v[164:167]
    v_mfma_f32_16x16x32_bf16 v[172:175], v[84:87], v[76:79], v[172:175]
    v_mfma_f32_16x16x32_bf16 v[180:183], v[88:91], v[76:79], v[180:183]
    v_mfma_f32_16x16x32_bf16 v[188:191], v[92:95], v[76:79], v[188:191]
    s_waitcnt lgkmcnt(9)
    v_mfma_f32_16x16x32_bf16 v[128:131], v[112:115], v[96:99], v[128:131]
    s_waitcnt lgkmcnt(6)
    v_mfma_f32_16x16x32_bf16 v[136:139], v[116:119], v[96:99], v[136:139]
    v_mfma_f32_16x16x32_bf16 v[132:135], v[112:115], v[100:103], v[132:135]
    v_mfma_f32_16x16x32_bf16 v[140:143], v[116:119], v[100:103], v[140:143]
    s_waitcnt lgkmcnt(0)
    s_barrier
    v_mfma_f32_16x16x32_bf16 v[144:147], v[120:123], v[96:99], v[144:147]
    ds_read_b64_tr_b16 v[80:81], v16 offset:0
    v_mfma_f32_16x16x32_bf16 v[148:151], v[120:123], v[100:103], v[148:151]
    ds_read_b64_tr_b16 v[82:83], v16 offset:1024
    v_mfma_f32_16x16x32_bf16 v[160:163], v[112:115], v[104:107], v[160:163]
    ds_read_b128 v[64:67], v14 offset:0
    v_mfma_f32_16x16x32_bf16 v[168:171], v[116:119], v[104:107], v[168:171]
    ds_read_b64_tr_b16 v[84:85], v17 offset:0
    v_mfma_f32_16x16x32_bf16 v[176:179], v[120:123], v[104:107], v[176:179]
    ds_read_b64_tr_b16 v[86:87], v17 offset:1024
    v_mfma_f32_16x16x32_bf16 v[152:155], v[124:127], v[96:99], v[152:155]
    ds_read_b128 v[68:71], v14 offset:2048
    v_mfma_f32_16x16x32_bf16 v[156:159], v[124:127], v[100:103], v[156:159]
    ds_read_b64_tr_b16 v[88:89], v18 offset:0
    v_mfma_f32_16x16x32_bf16 v[184:187], v[124:127], v[104:107], v[184:187]
    ds_read_b64_tr_b16 v[90:91], v18 offset:1024
    v_mfma_f32_16x16x32_bf16 v[164:167], v[112:115], v[108:111], v[164:167]
    ds_read_b128 v[72:75], v14 offset:4096
    v_mfma_f32_16x16x32_bf16 v[172:175], v[116:119], v[108:111], v[172:175]
    ds_read_b64_tr_b16 v[92:93], v19 offset:0
    v_mfma_f32_16x16x32_bf16 v[180:183], v[120:123], v[108:111], v[180:183]
    ds_read_b64_tr_b16 v[94:95], v19 offset:1024
    v_mfma_f32_16x16x32_bf16 v[188:191], v[124:127], v[108:111], v[188:191]
    ds_read_b128 v[76:79], v14 offset:6144
    s_waitcnt lgkmcnt(9)
    v_mfma_f32_16x16x32_bf16 v[128:131], v[80:83], v[64:67], v[128:131]
    ds_read_b64_tr_b16 v[112:113], v16 offset:8192
    s_waitcnt lgkmcnt(7)
    v_mfma_f32_16x16x32_bf16 v[136:139], v[84:87], v[64:67], v[136:139]
    ds_read_b64_tr_b16 v[114:115], v16 offset:9216
    v_mfma_f32_16x16x32_bf16 v[132:135], v[80:83], v[68:71], v[132:135]
    ds_read_b128 v[96:99], v15 offset:0
    v_mfma_f32_16x16x32_bf16 v[140:143], v[84:87], v[68:71], v[140:143]
    ds_read_b64_tr_b16 v[116:117], v17 offset:8192
    s_waitcnt lgkmcnt(7)
    v_mfma_f32_16x16x32_bf16 v[144:147], v[88:91], v[64:67], v[144:147]
    ds_read_b64_tr_b16 v[118:119], v17 offset:9216
    v_mfma_f32_16x16x32_bf16 v[148:151], v[88:91], v[68:71], v[148:151]
    ds_read_b128 v[100:103], v15 offset:2048
    v_mfma_f32_16x16x32_bf16 v[160:163], v[80:83], v[72:75], v[160:163]
    ds_read_b64_tr_b16 v[120:121], v18 offset:8192
    v_mfma_f32_16x16x32_bf16 v[168:171], v[84:87], v[72:75], v[168:171]
    ds_read_b64_tr_b16 v[122:123], v18 offset:9216
    v_mfma_f32_16x16x32_bf16 v[176:179], v[88:91], v[72:75], v[176:179]
    ds_read_b128 v[104:107], v15 offset:4096
    s_waitcnt lgkmcnt(9)
    v_mfma_f32_16x16x32_bf16 v[152:155], v[92:95], v[64:67], v[152:155]
    ds_read_b64_tr_b16 v[124:125], v19 offset:8192
    v_mfma_f32_16x16x32_bf16 v[156:159], v[92:95], v[68:71], v[156:159]
    ds_read_b64_tr_b16 v[126:127], v19 offset:9216
    v_mfma_f32_16x16x32_bf16 v[184:187], v[92:95], v[72:75], v[184:187]
    ds_read_b128 v[108:111], v15 offset:6144
    v_mfma_f32_16x16x32_bf16 v[164:167], v[80:83], v[76:79], v[164:167]
    v_mfma_f32_16x16x32_bf16 v[172:175], v[84:87], v[76:79], v[172:175]
    v_mfma_f32_16x16x32_bf16 v[180:183], v[88:91], v[76:79], v[180:183]
    v_mfma_f32_16x16x32_bf16 v[188:191], v[92:95], v[76:79], v[188:191]
    s_waitcnt lgkmcnt(9)
    v_mfma_f32_16x16x32_bf16 v[128:131], v[112:115], v[96:99], v[128:131]
    s_waitcnt lgkmcnt(6)
    v_mfma_f32_16x16x32_bf16 v[136:139], v[116:119], v[96:99], v[136:139]
    v_mfma_f32_16x16x32_bf16 v[132:135], v[112:115], v[100:103], v[132:135]
    v_mfma_f32_16x16x32_bf16 v[140:143], v[116:119], v[100:103], v[140:143]
    s_waitcnt lgkmcnt(0)
    s_barrier
    v_mfma_f32_16x16x32_bf16 v[144:147], v[120:123], v[96:99], v[144:147]
    ds_read_b64_tr_b16 v[80:81], v16 offset:32768
    v_mfma_f32_16x16x32_bf16 v[148:151], v[120:123], v[100:103], v[148:151]
    ds_read_b64_tr_b16 v[82:83], v16 offset:33792
    v_mfma_f32_16x16x32_bf16 v[160:163], v[112:115], v[104:107], v[160:163]
    ds_read_b128 v[64:67], v14 offset:32768
    v_mfma_f32_16x16x32_bf16 v[168:171], v[116:119], v[104:107], v[168:171]
    ds_read_b64_tr_b16 v[84:85], v17 offset:32768
    v_mfma_f32_16x16x32_bf16 v[176:179], v[120:123], v[104:107], v[176:179]
    ds_read_b64_tr_b16 v[86:87], v17 offset:33792
    v_mfma_f32_16x16x32_bf16 v[152:155], v[124:127], v[96:99], v[152:155]
    ds_read_b128 v[68:71], v14 offset:34816
    v_mfma_f32_16x16x32_bf16 v[156:159], v[124:127], v[100:103], v[156:159]
    ds_read_b64_tr_b16 v[88:89], v18 offset:32768
    v_mfma_f32_16x16x32_bf16 v[184:187], v[124:127], v[104:107], v[184:187]
    ds_read_b64_tr_b16 v[90:91], v18 offset:33792
    v_mfma_f32_16x16x32_bf16 v[164:167], v[112:115], v[108:111], v[164:167]
    ds_read_b128 v[72:75], v14 offset:36864
    v_mfma_f32_16x16x32_bf16 v[172:175], v[116:119], v[108:111], v[172:175]
    ds_read_b64_tr_b16 v[92:93], v19 offset:32768
    v_mfma_f32_16x16x32_bf16 v[180:183], v[120:123], v[108:111], v[180:183]
    ds_read_b64_tr_b16 v[94:95], v19 offset:33792
    v_mfma_f32_16x16x32_bf16 v[188:191], v[124:127], v[108:111], v[188:191]
    ds_read_b128 v[76:79], v14 offset:38912
    s_waitcnt lgkmcnt(9)
    v_mfma_f32_16x16x32_bf16 v[128:131], v[80:83], v[64:67], v[128:131]
    ds_read_b64_tr_b16 v[112:113], v16 offset:40960
    s_waitcnt lgkmcnt(7)
    v_mfma_f32_16x16x32_bf16 v[136:139], v[84:87], v[64:67], v[136:139]
    ds_read_b64_tr_b16 v[114:115], v16 offset:41984
    v_mfma_f32_16x16x32_bf16 v[132:135], v[80:83], v[68:71], v[132:135]
    ds_read_b128 v[96:99], v15 offset:32768
    v_mfma_f32_16x16x32_bf16 v[140:143], v[84:87], v[68:71], v[140:143]
    ds_read_b64_tr_b16 v[116:117], v17 offset:40960
    s_waitcnt lgkmcnt(7)
    v_mfma_f32_16x16x32_bf16 v[144:147], v[88:91], v[64:67], v[144:147]
    ds_read_b64_tr_b16 v[118:119], v17 offset:41984
    v_mfma_f32_16x16x32_bf16 v[148:151], v[88:91], v[68:71], v[148:151]
    ds_read_b128 v[100:103], v15 offset:34816
    v_mfma_f32_16x16x32_bf16 v[160:163], v[80:83], v[72:75], v[160:163]
    ds_read_b64_tr_b16 v[120:121], v18 offset:40960
    v_mfma_f32_16x16x32_bf16 v[168:171], v[84:87], v[72:75], v[168:171]
    ds_read_b64_tr_b16 v[122:123], v18 offset:41984
    v_mfma_f32_16x16x32_bf16 v[176:179], v[88:91], v[72:75], v[176:179]
    ds_read_b128 v[104:107], v15 offset:36864
    s_waitcnt lgkmcnt(9)
    v_mfma_f32_16x16x32_bf16 v[152:155], v[92:95], v[64:67], v[152:155]
    ds_read_b64_tr_b16 v[124:125], v19 offset:40960
    v_mfma_f32_16x16x32_bf16 v[156:159], v[92:95], v[68:71], v[156:159]
    ds_read_b64_tr_b16 v[126:127], v19 offset:41984
    v_mfma_f32_16x16x32_bf16 v[184:187], v[92:95], v[72:75], v[184:187]
    ds_read_b128 v[108:111], v15 offset:38912
    v_mfma_f32_16x16x32_bf16 v[164:167], v[80:83], v[76:79], v[164:167]
    v_mfma_f32_16x16x32_bf16 v[172:175], v[84:87], v[76:79], v[172:175]
    v_mfma_f32_16x16x32_bf16 v[180:183], v[88:91], v[76:79], v[180:183]
    v_mfma_f32_16x16x32_bf16 v[188:191], v[92:95], v[76:79], v[188:191]
    s_sub_u32 s10, s10, 1
    s_cmp_lg_u32 s10, 0
    s_cbranch_scc1 KF_CL0
    s_cmp_eq_u32 s14, 0
    s_cbranch_scc1 KF_NT0
    s_waitcnt lgkmcnt(0)
    s_barrier
KF_NT0:
    s_cmp_eq_u32 s15, 0
    s_cbranch_scc1 KF_EQ
    s_waitcnt lgkmcnt(0)
    v_mfma_f32_16x16x32_bf16 v[128:131], v[112:115], v[96:99], v[128:131]
    v_mfma_f32_16x16x32_bf16 v[136:139], v[116:119], v[96:99], v[136:139]
    v_mfma_f32_16x16x32_bf16 v[132:135], v[112:115], v[100:103], v[132:135]
    v_mfma_f32_16x16x32_bf16 v[140:143], v[116:119], v[100:103], v[140:143]
    v_mfma_f32_16x16x32_bf16 v[144:147], v[120:123], v[96:99], v[144:147]
    v_mfma_f32_16x16x32_bf16 v[152:155], v[124:127], v[96:99], v[152:155]
    v_mfma_f32_16x16x32_bf16 v[148:151], v[120:123], v[100:103], v[148:151]
    v_mfma_f32_16x16x32_bf16 v[156:159], v[124:127], v[100:103], v[156:159]
    v_mfma_f32_16x16x32_bf16 v[160:163], v[112:115], v[104:107], v[160:163]
    v_pk_mul_f32 v[128:129], v[128:129], s[58:59]
    v_pk_mul_f32 v[130:131], v[130:131], s[58:59]
    v_pk_mul_f32 v[132:133], v[132:133], s[58:59]
    v_pk_mul_f32 v[134:135], v[134:135], s[58:59]
    v_pk_mul_f32 v[136:137], v[136:137], s[58:59]
    v_pk_mul_f32 v[138:139], v[138:139], s[58:59]
    v_mfma_f32_16x16x32_bf16 v[168:171], v[116:119], v[104:107], v[168:171]
    v_pk_mul_f32 v[140:141], v[140:141], s[58:59]
    v_pk_mul_f32 v[142:143], v[142:143], s[58:59]
    s_add_u32 s13, s72, 0
    v_cvt_pk_bf16_f32 v128, v128, v129
    v_cvt_pk_bf16_f32 v129, v130, v131
    v_cvt_pk_bf16_f32 v130, v132, v133
    v_mfma_f32_16x16x32_bf16 v[164:167], v[112:115], v[108:111], v[164:167]
    v_cvt_pk_bf16_f32 v131, v134, v135
    v_cvt_pk_bf16_f32 v132, v136, v137
    v_cvt_pk_bf16_f32 v133, v138, v139
    v_cvt_pk_bf16_f32 v134, v140, v141
    v_cvt_pk_bf16_f32 v135, v142, v143
    v_permlane32_swap_b32 v128, v130
    v_mfma_f32_16x16x32_bf16 v[172:175], v[116:119], v[108:111], v[172:175]
    v_permlane32_swap_b32 v129, v131
    v_permlane32_swap_b32 v132, v134
    v_permlane32_swap_b32 v133, v135
    buffer_store_dwordx4 v[128:131], v7, s[52:55], s13 offen sc0 sc1
    buffer_store_dwordx4 v[132:135], v7, s[52:55], s13 offen offset:1024 sc0 sc1
    v_mfma_f32_16x16x32_bf16 v[176:179], v[120:123], v[104:107], v[176:179]
    v_pk_mul_f32 v[144:145], v[144:145], s[58:59]
    v_pk_mul_f32 v[146:147], v[146:147], s[58:59]
    v_pk_mul_f32 v[148:149], v[148:149], s[58:59]
    v_pk_mul_f32 v[150:151], v[150:151], s[58:59]
    v_pk_mul_f32 v[152:153], v[152:153], s[58:59]
    v_pk_mul_f32 v[154:155], v[154:155], s[58:59]
    v_mfma_f32_16x16x32_bf16 v[184:187], v[124:127], v[104:107], v[184:187]
    v_pk_mul_f32 v[156:157], v[156:157], s[58:59]
    v_pk_mul_f32 v[158:159], v[158:159], s[58:59]
    s_add_u32 s13, s72, 262144
    v_cvt_pk_bf16_f32 v144, v144, v145
    v_cvt_pk_bf16_f32 v145, v146, v147
    v_cvt_pk_bf16_f32 v146, v148, v149
    v_mfma_f32_16x16x32_bf16 v[180:183], v[120:123], v[108:111], v[180:183]
    v_cvt_pk_bf16_f32 v147, v150, v151
    v_cvt_pk_bf16_f32 v148, v152, v153
    v_cvt_pk_bf16_f32 v149, v154, v155
    v_cvt_pk_bf16_f32 v150, v156, v157
    v_cvt_pk_bf16_f32 v151, v158, v159
    v_permlane32_swap_b32 v144, v146
    v_mfma_f32_16x16x32_bf16 v[188:191], v[124:127], v[108:111], v[188:191]
    v_permlane32_swap_b32 v145, v147
    v_permlane32_swap_b32 v148, v150
    v_permlane32_swap_b32 v149, v151
    buffer_store_dwordx4 v[144:147], v7, s[52:55], s13 offen sc0 sc1
    buffer_store_dwordx4 v[148:151], v7, s[52:55], s13 offen offset:1024 sc0 sc1
    v_pk_mul_f32 v[160:161], v[160:161], s[58:59]
    v_pk_mul_f32 v[162:163], v[162:163], s[58:59]
    v_pk_mul_f32 v[164:165], v[164:165], s[58:59]
    v_pk_mul_f32 v[166:167], v[166:167], s[58:59]
    v_pk_mul_f32 v[168:169], v[168:169], s[58:59]
    v_pk_mul_f32 v[170:171], v[170:171], s[58:59]
    v_pk_mul_f32 v[172:173], v[172:173], s[58:59]
    v_pk_mul_f32 v[174:175], v[174:175], s[58:59]
    s_add_u32 s13, s72, 4096
    v_cvt_pk_bf16_f32 v160, v160, v161
    v_cvt_pk_bf16_f32 v161, v162, v163
    v_cvt_pk_bf16_f32 v162, v164, v165
    v_cvt_pk_bf16_f32 v163, v166, v167
    v_cvt_pk_bf16_f32 v164, v168, v169
    v_cvt_pk_bf16_f32 v165, v170, v171
    v_cvt_pk_bf16_f32 v166, v172, v173
    v_cvt_pk_bf16_f32 v167, v174, v175
    v_permlane32_swap_b32 v160, v162
    v_permlane32_swap_b32 v161, v163
    v_permlane32_swap_b32 v164, v166
    v_permlane32_swap_b32 v165, v167
    buffer_store_dwordx4 v[160:163], v7, s[52:55], s13 offen sc0 sc1
    buffer_store_dwordx4 v[164:167], v7, s[52:55], s13 offen offset:1024 sc0 sc1
    v_pk_mul_f32 v[176:177], v[176:177], s[58:59]
    v_pk_mul_f32 v[178:179], v[178:179], s[58:59]
    v_pk_mul_f32 v[180:181], v[180:181], s[58:59]
    v_pk_mul_f32 v[182:183], v[182:183], s[58:59]
    v_pk_mul_f32 v[184:185], v[184:185], s[58:59]
    v_pk_mul_f32 v[186:187], v[186:187], s[58:59]
    v_pk_mul_f32 v[188:189], v[188:189], s[58:59]
    v_pk_mul_f32 v[190:191], v[190:191], s[58:59]
    s_add_u32 s13, s72, 266240
    v_cvt_pk_bf16_f32 v176, v176, v177
    v_cvt_pk_bf16_f32 v177, v178, v179
    v_cvt_pk_bf16_f32 v178, v180, v181
    v_cvt_pk_bf16_f32 v179, v182, v183
    v_cvt_pk_bf16_f32 v180, v184, v185
    v_cvt_pk_bf16_f32 v181, v186, v187
    v_cvt_pk_bf16_f32 v182, v188, v189
    v_cvt_pk_bf16_f32 v183, v190, v191
    v_permlane32_swap_b32 v176, v178
    v_permlane32_swap_b32 v177, v179
    v_permlane32_swap_b32 v180, v182
    v_permlane32_swap_b32 v181, v183
    buffer_store_dwordx4 v[176:179], v7, s[52:55], s13 offen sc0 sc1
    buffer_store_dwordx4 v[180:183], v7, s[52:55], s13 offen offset:1024 sc0 sc1
    s_branch KF_EN
KF_CV:
    s_barrier
    ds_read_b64_tr_b16 v[80:81], v10 offset:0
    ds_read_b64_tr_b16 v[82:83], v10 offset:1024
    ds_read_b128 v[64:67], v8 offset:0
    ds_read_b64_tr_b16 v[84:85], v11 offset:0
    ds_read_b64_tr_b16 v[86:87], v11 offset:1024
    ds_read_b128 v[68:71], v8 offset:2048
    ds_read_b64_tr_b16 v[88:89], v12 offset:0
    ds_read_b64_tr_b16 v[90:91], v12 offset:1024
    ds_read_b128 v[72:75], v8 offset:4096
    ds_read_b64_tr_b16 v[92:93], v13 offset:0
    ds_read_b64_tr_b16 v[94:95], v13 offset:1024
    ds_read_b128 v[76:79], v8 offset:6144
    s_waitcnt lgkmcnt(9)
    v_mfma_f32_16x16x32_bf16 v[128:131], v[64:67], v[80:83], 0
    ds_read_b64_tr_b16 v[112:113], v10 offset:8192
    s_waitcnt lgkmcnt(7)
    v_mfma_f32_16x16x32_bf16 v[132:135], v[64:67], v[84:87], 0
    ds_read_b64_tr_b16 v[114:115], v10 offset:9216
    v_mfma_f32_16x16x32_bf16 v[136:139], v[68:71], v[80:83], 0
    ds_read_b128 v[96:99], v9 offset:0
    v_mfma_f32_16x16x32_bf16 v[140:143], v[68:71], v[84:87], 0
    ds_read_b64_tr_b16 v[116:117], v11 offset:8192
    s_waitcnt lgkmcnt(7)
    v_mfma_f32_16x16x32_bf16 v[144:147], v[64:67], v[88:91], 0
    ds_read_b64_tr_b16 v[118:119], v11 offset:9216
    v_mfma_f32_16x16x32_bf16 v[152:155], v[68:71], v[88:91], 0
    ds_read_b128 v[100:103], v9 offset:2048
    v_mfma_f32_16x16x32_bf16 v[160:163], v[72:75], v[80:83], 0
    ds_read_b64_tr_b16 v[120:121], v12 offset:8192
    v_mfma_f32_16x16x32_bf16 v[164:167], v[72:75], v[84:87], 0
    ds_read_b64_tr_b16 v[122:123], v12 offset:9216
    v_mfma_f32_16x16x32_bf16 v[176:179], v[72:75], v[88:91], 0
    ds_read_b128 v[104:107], v9 offset:4096
    s_waitcnt lgkmcnt(9)
    v_mfma_f32_16x16x32_bf16 v[148:151], v[64:67], v[92:95], 0
    ds_read_b64_tr_b16 v[124:125], v13 offset:8192
    v_mfma_f32_16x16x32_bf16 v[156:159], v[68:71], v[92:95], 0
    ds_read_b64_tr_b16 v[126:127], v13 offset:9216
    v_mfma_f32_16x16x32_bf16 v[180:183], v[72:75], v[92:95], 0
    ds_read_b128 v[108:111], v9 offset:6144
    v_mfma_f32_16x16x32_bf16 v[168:171], v[76:79], v[80:83], 0
    v_mfma_f32_16x16x32_bf16 v[172:175], v[76:79], v[84:87], 0
    v_mfma_f32_16x16x32_bf16 v[184:187], v[76:79], v[88:91], 0
    v_mfma_f32_16x16x32_bf16 v[188:191], v[76:79], v[92:95], 0
    s_branch KF_CL1_E
.p2align 6
KF_CL1:
    s_waitcnt lgkmcnt(9)
    v_mfma_f32_16x16x32_bf16 v[128:131], v[96:99], v[112:115], v[128:131]
    s_waitcnt lgkmcnt(6)
    v_mfma_f32_16x16x32_bf16 v[132:135], v[96:99], v[116:119], v[132:135]
    v_mfma_f32_16x16x32_bf16 v[136:139], v[100:103], v[112:115], v[136:139]
    v_mfma_f32_16x16x32_bf16 v[140:143], v[100:103], v[116:119], v[140:143]
    s_waitcnt lgkmcnt(0) vmcnt(0)
    s_barrier
    v_mfma_f32_16x16x32_bf16 v[144:147], v[96:99], v[120:123], v[144:147]
    ds_read_b64_tr_b16 v[80:81], v10 offset:0
    v_mfma_f32_16x16x32_bf16 v[152:155], v[100:103], v[120:123], v[152:155]
    ds_read_b64_tr_b16 v[82:83], v10 offset:1024
    v_mfma_f32_16x16x32_bf16 v[160:163], v[104:107], v[112:115], v[160:163]
    ds_read_b128 v[64:67], v8 offset:0
    v_mfma_f32_16x16x32_bf16 v[164:167], v[104:107], v[116:119], v[164:167]
    ds_read_b64_tr_b16 v[84:85], v11 offset:0
    v_mfma_f32_16x16x32_bf16 v[176:179], v[104:107], v[120:123], v[176:179]
    ds_read_b64_tr_b16 v[86:87], v11 offset:1024
    v_mfma_f32_16x16x32_bf16 v[148:151], v[96:99], v[124:127], v[148:151]
    ds_read_b128 v[68:71], v8 offset:2048
    v_mfma_f32_16x16x32_bf16 v[156:159], v[100:103], v[124:127], v[156:159]
    ds_read_b64_tr_b16 v[88:89], v12 offset:0
    v_mfma_f32_16x16x32_bf16 v[180:183], v[104:107], v[124:127], v[180:183]
    ds_read_b64_tr_b16 v[90:91], v12 offset:1024
    v_mfma_f32_16x16x32_bf16 v[168:171], v[108:111], v[112:115], v[168:171]
    ds_read_b128 v[72:75], v8 offset:4096
    v_mfma_f32_16x16x32_bf16 v[172:175], v[108:111], v[116:119], v[172:175]
    ds_read_b64_tr_b16 v[92:93], v13 offset:0
    v_mfma_f32_16x16x32_bf16 v[184:187], v[108:111], v[120:123], v[184:187]
    ds_read_b64_tr_b16 v[94:95], v13 offset:1024
    v_mfma_f32_16x16x32_bf16 v[188:191], v[108:111], v[124:127], v[188:191]
    ds_read_b128 v[76:79], v8 offset:6144
    s_waitcnt lgkmcnt(9)
    v_mfma_f32_16x16x32_bf16 v[128:131], v[64:67], v[80:83], v[128:131]
    ds_read_b64_tr_b16 v[112:113], v10 offset:8192
    s_waitcnt lgkmcnt(7)
    v_mfma_f32_16x16x32_bf16 v[132:135], v[64:67], v[84:87], v[132:135]
    ds_read_b64_tr_b16 v[114:115], v10 offset:9216
    v_mfma_f32_16x16x32_bf16 v[136:139], v[68:71], v[80:83], v[136:139]
    ds_read_b128 v[96:99], v9 offset:0
    v_mfma_f32_16x16x32_bf16 v[140:143], v[68:71], v[84:87], v[140:143]
    ds_read_b64_tr_b16 v[116:117], v11 offset:8192
    s_waitcnt lgkmcnt(7)
    v_mfma_f32_16x16x32_bf16 v[144:147], v[64:67], v[88:91], v[144:147]
    ds_read_b64_tr_b16 v[118:119], v11 offset:9216
    v_mfma_f32_16x16x32_bf16 v[152:155], v[68:71], v[88:91], v[152:155]
    ds_read_b128 v[100:103], v9 offset:2048
    v_mfma_f32_16x16x32_bf16 v[160:163], v[72:75], v[80:83], v[160:163]
    ds_read_b64_tr_b16 v[120:121], v12 offset:8192
    v_mfma_f32_16x16x32_bf16 v[164:167], v[72:75], v[84:87], v[164:167]
    ds_read_b64_tr_b16 v[122:123], v12 offset:9216
    v_mfma_f32_16x16x32_bf16 v[176:179], v[72:75], v[88:91], v[176:179]
    ds_read_b128 v[104:107], v9 offset:4096
    s_waitcnt lgkmcnt(9)
    v_mfma_f32_16x16x32_bf16 v[148:151], v[64:67], v[92:95], v[148:151]
    ds_read_b64_tr_b16 v[124:125], v13 offset:8192
    v_mfma_f32_16x16x32_bf16 v[156:159], v[68:71], v[92:95], v[156:159]
    ds_read_b64_tr_b16 v[126:127], v13 offset:9216
    v_mfma_f32_16x16x32_bf16 v[180:183], v[72:75], v[92:95], v[180:183]
    ds_read_b128 v[108:111], v9 offset:6144
    v_mfma_f32_16x16x32_bf16 v[168:171], v[76:79], v[80:83], v[168:171]
    v_mfma_f32_16x16x32_bf16 v[172:175], v[76:79], v[84:87], v[172:175]
    v_mfma_f32_16x16x32_bf16 v[184:187], v[76:79], v[88:91], v[184:187]
    v_mfma_f32_16x16x32_bf16 v[188:191], v[76:79], v[92:95], v[188:191]
KF_CL1_E:
    s_waitcnt lgkmcnt(9)
    v_mfma_f32_16x16x32_bf16 v[128:131], v[96:99], v[112:115], v[128:131]
    s_waitcnt lgkmcnt(6)
    v_mfma_f32_16x16x32_bf16 v[132:135], v[96:99], v[116:119], v[132:135]
    v_mfma_f32_16x16x32_bf16 v[136:139], v[100:103], v[112:115], v[136:139]
    v_mfma_f32_16x16x32_bf16 v[140:143], v[100:103], v[116:119], v[140:143]
    s_waitcnt lgkmcnt(0)
    s_barrier
    v_mfma_f32_16x16x32_bf16 v[144:147], v[96:99], v[120:123], v[144:147]
    ds_read_b64_tr_b16 v[80:81], v10 offset:32768
    v_mfma_f32_16x16x32_bf16 v[152:155], v[100:103], v[120:123], v[152:155]
    ds_read_b64_tr_b16 v[82:83], v10 offset:33792
    v_mfma_f32_16x16x32_bf16 v[160:163], v[104:107], v[112:115], v[160:163]
    ds_read_b128 v[64:67], v8 offset:32768
    v_mfma_f32_16x16x32_bf16 v[164:167], v[104:107], v[116:119], v[164:167]
    ds_read_b64_tr_b16 v[84:85], v11 offset:32768
    v_mfma_f32_16x16x32_bf16 v[176:179], v[104:107], v[120:123], v[176:179]
    ds_read_b64_tr_b16 v[86:87], v11 offset:33792
    v_mfma_f32_16x16x32_bf16 v[148:151], v[96:99], v[124:127], v[148:151]
    ds_read_b128 v[68:71], v8 offset:34816
    v_mfma_f32_16x16x32_bf16 v[156:159], v[100:103], v[124:127], v[156:159]
    ds_read_b64_tr_b16 v[88:89], v12 offset:32768
    v_mfma_f32_16x16x32_bf16 v[180:183], v[104:107], v[124:127], v[180:183]
    ds_read_b64_tr_b16 v[90:91], v12 offset:33792
    v_mfma_f32_16x16x32_bf16 v[168:171], v[108:111], v[112:115], v[168:171]
    ds_read_b128 v[72:75], v8 offset:36864
    v_mfma_f32_16x16x32_bf16 v[172:175], v[108:111], v[116:119], v[172:175]
    ds_read_b64_tr_b16 v[92:93], v13 offset:32768
    v_mfma_f32_16x16x32_bf16 v[184:187], v[108:111], v[120:123], v[184:187]
    ds_read_b64_tr_b16 v[94:95], v13 offset:33792
    v_mfma_f32_16x16x32_bf16 v[188:191], v[108:111], v[124:127], v[188:191]
    ds_read_b128 v[76:79], v8 offset:38912
    s_waitcnt lgkmcnt(9)
    v_mfma_f32_16x16x32_bf16 v[128:131], v[64:67], v[80:83], v[128:131]
    ds_read_b64_tr_b16 v[112:113], v10 offset:40960
    s_waitcnt lgkmcnt(7)
    v_mfma_f32_16x16x32_bf16 v[132:135], v[64:67], v[84:87], v[132:135]
    ds_read_b64_tr_b16 v[114:115], v10 offset:41984
    v_mfma_f32_16x16x32_bf16 v[136:139], v[68:71], v[80:83], v[136:139]
    ds_read_b128 v[96:99], v9 offset:32768
    v_mfma_f32_16x16x32_bf16 v[140:143], v[68:71], v[84:87], v[140:143]
    ds_read_b64_tr_b16 v[116:117], v11 offset:40960
    s_waitcnt lgkmcnt(7)
    v_mfma_f32_16x16x32_bf16 v[144:147], v[64:67], v[88:91], v[144:147]
    ds_read_b64_tr_b16 v[118:119], v11 offset:41984
    v_mfma_f32_16x16x32_bf16 v[152:155], v[68:71], v[88:91], v[152:155]
    ds_read_b128 v[100:103], v9 offset:34816
    v_mfma_f32_16x16x32_bf16 v[160:163], v[72:75], v[80:83], v[160:163]
    ds_read_b64_tr_b16 v[120:121], v12 offset:40960
    v_mfma_f32_16x16x32_bf16 v[164:167], v[72:75], v[84:87], v[164:167]
    ds_read_b64_tr_b16 v[122:123], v12 offset:41984
    v_mfma_f32_16x16x32_bf16 v[176:179], v[72:75], v[88:91], v[176:179]
    ds_read_b128 v[104:107], v9 offset:36864
    s_waitcnt lgkmcnt(9)
    v_mfma_f32_16x16x32_bf16 v[148:151], v[64:67], v[92:95], v[148:151]
    ds_read_b64_tr_b16 v[124:125], v13 offset:40960
    v_mfma_f32_16x16x32_bf16 v[156:159], v[68:71], v[92:95], v[156:159]
    ds_read_b64_tr_b16 v[126:127], v13 offset:41984
    v_mfma_f32_16x16x32_bf16 v[180:183], v[72:75], v[92:95], v[180:183]
    ds_read_b128 v[108:111], v9 offset:38912
    v_mfma_f32_16x16x32_bf16 v[168:171], v[76:79], v[80:83], v[168:171]
    v_mfma_f32_16x16x32_bf16 v[172:175], v[76:79], v[84:87], v[172:175]
    v_mfma_f32_16x16x32_bf16 v[184:187], v[76:79], v[88:91], v[184:187]
    v_mfma_f32_16x16x32_bf16 v[188:191], v[76:79], v[92:95], v[188:191]
    s_waitcnt lgkmcnt(9)
    v_mfma_f32_16x16x32_bf16 v[128:131], v[96:99], v[112:115], v[128:131]
    s_waitcnt lgkmcnt(6)
    v_mfma_f32_16x16x32_bf16 v[132:135], v[96:99], v[116:119], v[132:135]
    v_mfma_f32_16x16x32_bf16 v[136:139], v[100:103], v[112:115], v[136:139]
    v_mfma_f32_16x16x32_bf16 v[140:143], v[100:103], v[116:119], v[140:143]
    s_waitcnt lgkmcnt(0)
    s_barrier
    v_mfma_f32_16x16x32_bf16 v[144:147], v[96:99], v[120:123], v[144:147]
    ds_read_b64_tr_b16 v[80:81], v16 offset:0
    v_mfma_f32_16x16x32_bf16 v[152:155], v[100:103], v[120:123], v[152:155]
    ds_read_b64_tr_b16 v[82:83], v16 offset:1024
    v_mfma_f32_16x16x32_bf16 v[160:163], v[104:107], v[112:115], v[160:163]
    ds_read_b128 v[64:67], v14 offset:0
    v_mfma_f32_16x16x32_bf16 v[164:167], v[104:107], v[116:119], v[164:167]
    ds_read_b64_tr_b16 v[84:85], v17 offset:0
    v_mfma_f32_16x16x32_bf16 v[176:179], v[104:107], v[120:123], v[176:179]
    ds_read_b64_tr_b16 v[86:87], v17 offset:1024
    v_mfma_f32_16x16x32_bf16 v[148:151], v[96:99], v[124:127], v[148:151]
    ds_read_b128 v[68:71], v14 offset:2048
    v_mfma_f32_16x16x32_bf16 v[156:159], v[100:103], v[124:127], v[156:159]
    ds_read_b64_tr_b16 v[88:89], v18 offset:0
    v_mfma_f32_16x16x32_bf16 v[180:183], v[104:107], v[124:127], v[180:183]
    ds_read_b64_tr_b16 v[90:91], v18 offset:1024
    v_mfma_f32_16x16x32_bf16 v[168:171], v[108:111], v[112:115], v[168:171]
    ds_read_b128 v[72:75], v14 offset:4096
    v_mfma_f32_16x16x32_bf16 v[172:175], v[108:111], v[116:119], v[172:175]
    ds_read_b64_tr_b16 v[92:93], v19 offset:0
    v_mfma_f32_16x16x32_bf16 v[184:187], v[108:111], v[120:123], v[184:187]
    ds_read_b64_tr_b16 v[94:95], v19 offset:1024
    v_mfma_f32_16x16x32_bf16 v[188:191], v[108:111], v[124:127], v[188:191]
    ds_read_b128 v[76:79], v14 offset:6144
    s_waitcnt lgkmcnt(9)
    v_mfma_f32_16x16x32_bf16 v[128:131], v[64:67], v[80:83], v[128:131]
    ds_read_b64_tr_b16 v[112:113], v16 offset:8192
    s_waitcnt lgkmcnt(7)
    v_mfma_f32_16x16x32_bf16 v[132:135], v[64:67], v[84:87], v[132:135]
    ds_read_b64_tr_b16 v[114:115], v16 offset:9216
    v_mfma_f32_16x16x32_bf16 v[136:139], v[68:71], v[80:83], v[136:139]
    ds_read_b128 v[96:99], v15 offset:0
    v_mfma_f32_16x16x32_bf16 v[140:143], v[68:71], v[84:87], v[140:143]
    ds_read_b64_tr_b16 v[116:117], v17 offset:8192
    s_waitcnt lgkmcnt(7)
    v_mfma_f32_16x16x32_bf16 v[144:147], v[64:67], v[88:91], v[144:147]
    ds_read_b64_tr_b16 v[118:119], v17 offset:9216
    v_mfma_f32_16x16x32_bf16 v[152:155], v[68:71], v[88:91], v[152:155]
    ds_read_b128 v[100:103], v15 offset:2048
    v_mfma_f32_16x16x32_bf16 v[160:163], v[72:75], v[80:83], v[160:163]
    ds_read_b64_tr_b16 v[120:121], v18 offset:8192
    v_mfma_f32_16x16x32_bf16 v[164:167], v[72:75], v[84:87], v[164:167]
    ds_read_b64_tr_b16 v[122:123], v18 offset:9216
    v_mfma_f32_16x16x32_bf16 v[176:179], v[72:75], v[88:91], v[176:179]
    ds_read_b128 v[104:107], v15 offset:4096
    s_waitcnt lgkmcnt(9)
    v_mfma_f32_16x16x32_bf16 v[148:151], v[64:67], v[92:95], v[148:151]
    ds_read_b64_tr_b16 v[124:125], v19 offset:8192
    v_mfma_f32_16x16x32_bf16 v[156:159], v[68:71], v[92:95], v[156:159]
    ds_read_b64_tr_b16 v[126:127], v19 offset:9216
    v_mfma_f32_16x16x32_bf16 v[180:183], v[72:75], v[92:95], v[180:183]
    ds_read_b128 v[108:111], v15 offset:6144
    v_mfma_f32_16x16x32_bf16 v[168:171], v[76:79], v[80:83], v[168:171]
    v_mfma_f32_16x16x32_bf16 v[172:175], v[76:79], v[84:87], v[172:175]
    v_mfma_f32_16x16x32_bf16 v[184:187], v[76:79], v[88:91], v[184:187]
    v_mfma_f32_16x16x32_bf16 v[188:191], v[76:79], v[92:95], v[188:191]
    s_waitcnt lgkmcnt(9)
    v_mfma_f32_16x16x32_bf16 v[128:131], v[96:99], v[112:115], v[128:131]
    s_waitcnt lgkmcnt(6)
    v_mfma_f32_16x16x32_bf16 v[132:135], v[96:99], v[116:119], v[132:135]
    v_mfma_f32_16x16x32_bf16 v[136:139], v[100:103], v[112:115], v[136:139]
    v_mfma_f32_16x16x32_bf16 v[140:143], v[100:103], v[116:119], v[140:143]
    s_waitcnt lgkmcnt(0)
    s_barrier
    v_mfma_f32_16x16x32_bf16 v[144:147], v[96:99], v[120:123], v[144:147]
    ds_read_b64_tr_b16 v[80:81], v16 offset:32768
    v_mfma_f32_16x16x32_bf16 v[152:155], v[100:103], v[120:123], v[152:155]
    ds_read_b64_tr_b16 v[82:83], v16 offset:33792
    v_mfma_f32_16x16x32_bf16 v[160:163], v[104:107], v[112:115], v[160:163]
    ds_read_b128 v[64:67], v14 offset:32768
    v_mfma_f32_16x16x32_bf16 v[164:167], v[104:107], v[116:119], v[164:167]
    ds_read_b64_tr_b16 v[84:85], v17 offset:32768
    v_mfma_f32_16x16x32_bf16 v[176:179], v[104:107], v[120:123], v[176:179]
    ds_read_b64_tr_b16 v[86:87], v17 offset:33792
    v_mfma_f32_16x16x32_bf16 v[148:151], v[96:99], v[124:127], v[148:151]
    ds_read_b128 v[68:71], v14 offset:34816
    v_mfma_f32_16x16x32_bf16 v[156:159], v[100:103], v[124:127], v[156:159]
    ds_read_b64_tr_b16 v[88:89], v18 offset:32768
    v_mfma_f32_16x16x32_bf16 v[180:183], v[104:107], v[124:127], v[180:183]
    ds_read_b64_tr_b16 v[90:91], v18 offset:33792
    v_mfma_f32_16x16x32_bf16 v[168:171], v[108:111], v[112:115], v[168:171]
    ds_read_b128 v[72:75], v14 offset:36864
    v_mfma_f32_16x16x32_bf16 v[172:175], v[108:111], v[116:119], v[172:175]
    ds_read_b64_tr_b16 v[92:93], v19 offset:32768
    v_mfma_f32_16x16x32_bf16 v[184:187], v[108:111], v[120:123], v[184:187]
    ds_read_b64_tr_b16 v[94:95], v19 offset:33792
    v_mfma_f32_16x16x32_bf16 v[188:191], v[108:111], v[124:127], v[188:191]
    ds_read_b128 v[76:79], v14 offset:38912
    s_waitcnt lgkmcnt(9)
    v_mfma_f32_16x16x32_bf16 v[128:131], v[64:67], v[80:83], v[128:131]
    ds_read_b64_tr_b16 v[112:113], v16 offset:40960
    s_waitcnt lgkmcnt(7)
    v_mfma_f32_16x16x32_bf16 v[132:135], v[64:67], v[84:87], v[132:135]
    ds_read_b64_tr_b16 v[114:115], v16 offset:41984
    v_mfma_f32_16x16x32_bf16 v[136:139], v[68:71], v[80:83], v[136:139]
    ds_read_b128 v[96:99], v15 offset:32768
    v_mfma_f32_16x16x32_bf16 v[140:143], v[68:71], v[84:87], v[140:143]
    ds_read_b64_tr_b16 v[116:117], v17 offset:40960
    s_waitcnt lgkmcnt(7)
    v_mfma_f32_16x16x32_bf16 v[144:147], v[64:67], v[88:91], v[144:147]
    ds_read_b64_tr_b16 v[118:119], v17 offset:41984
    v_mfma_f32_16x16x32_bf16 v[152:155], v[68:71], v[88:91], v[152:155]
    ds_read_b128 v[100:103], v15 offset:34816
    v_mfma_f32_16x16x32_bf16 v[160:163], v[72:75], v[80:83], v[160:163]
    ds_read_b64_tr_b16 v[120:121], v18 offset:40960
    v_mfma_f32_16x16x32_bf16 v[164:167], v[72:75], v[84:87], v[164:167]
    ds_read_b64_tr_b16 v[122:123], v18 offset:41984
    v_mfma_f32_16x16x32_bf16 v[176:179], v[72:75], v[88:91], v[176:179]
    ds_read_b128 v[104:107], v15 offset:36864
    s_waitcnt lgkmcnt(9)
    v_mfma_f32_16x16x32_bf16 v[148:151], v[64:67], v[92:95], v[148:151]
    ds_read_b64_tr_b16 v[124:125], v19 offset:40960
    v_mfma_f32_16x16x32_bf16 v[156:159], v[68:71], v[92:95], v[156:159]
    ds_read_b64_tr_b16 v[126:127], v19 offset:41984
    v_mfma_f32_16x16x32_bf16 v[180:183], v[72:75], v[92:95], v[180:183]
    ds_read_b128 v[108:111], v15 offset:38912
    v_mfma_f32_16x16x32_bf16 v[168:171], v[76:79], v[80:83], v[168:171]
    v_mfma_f32_16x16x32_bf16 v[172:175], v[76:79], v[84:87], v[172:175]
    v_mfma_f32_16x16x32_bf16 v[184:187], v[76:79], v[88:91], v[184:187]
    v_mfma_f32_16x16x32_bf16 v[188:191], v[76:79], v[92:95], v[188:191]
    s_sub_u32 s10, s10, 1
    s_cmp_lg_u32 s10, 0
    s_cbranch_scc1 KF_CL1
    s_cmp_eq_u32 s14, 0
    s_cbranch_scc1 KF_NT1
    s_waitcnt lgkmcnt(0)
    s_barrier
KF_NT1:
    s_waitcnt lgkmcnt(0)
    v_mfma_f32_16x16x32_bf16 v[128:131], v[96:99], v[112:115], v[128:131]
    v_mfma_f32_16x16x32_bf16 v[132:135], v[96:99], v[116:119], v[132:135]
    v_mfma_f32_16x16x32_bf16 v[136:139], v[100:103], v[112:115], v[136:139]
    v_mfma_f32_16x16x32_bf16 v[140:143], v[100:103], v[116:119], v[140:143]
    v_mfma_f32_16x16x32_bf16 v[144:147], v[96:99], v[120:123], v[144:147]
    v_mfma_f32_16x16x32_bf16 v[148:151], v[96:99], v[124:127], v[148:151]
    v_mfma_f32_16x16x32_bf16 v[152:155], v[100:103], v[120:123], v[152:155]
    v_mfma_f32_16x16x32_bf16 v[156:159], v[100:103], v[124:127], v[156:159]
    v_mfma_f32_16x16x32_bf16 v[160:163], v[104:107], v[112:115], v[160:163]
    s_add_u32 s13, s72, 0
    v_cvt_pk_bf16_f32 v128, v128, v129
    v_cvt_pk_bf16_f32 v129, v130, v131
    v_cvt_pk_bf16_f32 v130, v132, v133
    v_mfma_f32_16x16x32_bf16 v[164:167], v[104:107], v[116:119], v[164:167]
    v_cvt_pk_bf16_f32 v131, v134, v135
    v_cvt_pk_bf16_f32 v132, v136, v137
    v_cvt_pk_bf16_f32 v133, v138, v139
    v_cvt_pk_bf16_f32 v134, v140, v141
    v_mfma_f32_16x16x32_bf16 v[168:171], v[108:111], v[112:115], v[168:171]
    v_cvt_pk_bf16_f32 v135, v142, v143
    v_permlane32_swap_b32 v128, v130
    v_permlane32_swap_b32 v129, v131
    v_permlane32_swap_b32 v132, v134
    v_mfma_f32_16x16x32_bf16 v[172:175], v[108:111], v[116:119], v[172:175]
    v_permlane32_swap_b32 v133, v135
    buffer_store_dwordx4 v[128:131], v7, s[52:55], s13 offen sc0 sc1
    buffer_store_dwordx4 v[132:135], v7, s[52:55], s13 offen offset:1024 sc0 sc1
    v_mfma_f32_16x16x32_bf16 v[176:179], v[104:107], v[120:123], v[176:179]
    s_add_u32 s13, s72, 262144
    v_cvt_pk_bf16_f32 v144, v144, v145
    v_cvt_pk_bf16_f32 v145, v146, v147
    v_cvt_pk_bf16_f32 v146, v148, v149
    v_mfma_f32_16x16x32_bf16 v[180:183], v[104:107], v[124:127], v[180:183]
    v_cvt_pk_bf16_f32 v147, v150, v151
    v_cvt_pk_bf16_f32 v148, v152, v153
    v_cvt_pk_bf16_f32 v149, v154, v155
    v_cvt_pk_bf16_f32 v150, v156, v157
    v_mfma_f32_16x16x32_bf16 v[184:187], v[108:111], v[120:123], v[184:187]
    v_cvt_pk_bf16_f32 v151, v158, v159
    v_permlane32_swap_b32 v144, v146
    v_permlane32_swap_b32 v145, v147
    v_permlane32_swap_b32 v148, v150
    v_mfma_f32_16x16x32_bf16 v[188:191], v[108:111], v[124:127], v[188:191]
    v_permlane32_swap_b32 v149, v151
    buffer_store_dwordx4 v[144:147], v7, s[52:55], s13 offen sc0 sc1
    buffer_store_dwordx4 v[148:151], v7, s[52:55], s13 offen offset:1024 sc0 sc1
    s_add_u32 s13, s72, 4096
    v_cvt_pk_bf16_f32 v160, v160, v161
    v_cvt_pk_bf16_f32 v161, v162, v163
    v_cvt_pk_bf16_f32 v162, v164, v165
    v_cvt_pk_bf16_f32 v163, v166, v167
    v_cvt_pk_bf16_f32 v164, v168, v169
    v_cvt_pk_bf16_f32 v165, v170, v171
    v_cvt_pk_bf16_f32 v166, v172, v173
    v_cvt_pk_bf16_f32 v167, v174, v175
    v_permlane32_swap_b32 v160, v162
    v_permlane32_swap_b32 v161, v163
    v_permlane32_swap_b32 v164, v166
    v_permlane32_swap_b32 v165, v167
    buffer_store_dwordx4 v[160:163], v7, s[52:55], s13 offen sc0 sc1
    buffer_store_dwordx4 v[164:167], v7, s[52:55], s13 offen offset:1024 sc0 sc1
    s_add_u32 s13, s72, 266240
    v_cvt_pk_bf16_f32 v176, v176, v177
    v_cvt_pk_bf16_f32 v177, v178, v179
    v_cvt_pk_bf16_f32 v178, v180, v181
    v_cvt_pk_bf16_f32 v179, v182, v183
    v_cvt_pk_bf16_f32 v180, v184, v185
    v_cvt_pk_bf16_f32 v181, v186, v187
    v_cvt_pk_bf16_f32 v182, v188, v189
    v_cvt_pk_bf16_f32 v183, v190, v191
    v_permlane32_swap_b32 v176, v178
    v_permlane32_swap_b32 v177, v179
    v_permlane32_swap_b32 v180, v182
    v_permlane32_swap_b32 v181, v183
    buffer_store_dwordx4 v[176:179], v7, s[52:55], s13 offen sc0 sc1
    buffer_store_dwordx4 v[180:183], v7, s[52:55], s13 offen offset:1024 sc0 sc1
    s_branch KF_EN
KF_EQ:
    s_waitcnt lgkmcnt(0)
    v_mfma_f32_16x16x32_bf16 v[128:131], v[112:115], v[96:99], v[128:131]
    v_mfma_f32_16x16x32_bf16 v[136:139], v[116:119], v[96:99], v[136:139]
    v_mfma_f32_16x16x32_bf16 v[132:135], v[112:115], v[100:103], v[132:135]
    v_mfma_f32_16x16x32_bf16 v[140:143], v[116:119], v[100:103], v[140:143]
    v_mfma_f32_16x16x32_bf16 v[144:147], v[120:123], v[96:99], v[144:147]
    v_mfma_f32_16x16x32_bf16 v[152:155], v[124:127], v[96:99], v[152:155]
    v_mfma_f32_16x16x32_bf16 v[148:151], v[120:123], v[100:103], v[148:151]
    v_mfma_f32_16x16x32_bf16 v[156:159], v[124:127], v[100:103], v[156:159]
    v_mfma_f32_16x16x32_bf16 v[160:163], v[112:115], v[104:107], v[160:163]
    v_cvt_pk_bf16_f32 v192, v128, v129
    v_cvt_pk_bf16_f32 v193, v130, v131
    v_cvt_pk_bf16_f32 v194, v132, v133
    v_mfma_f32_16x16x32_bf16 v[168:171], v[116:119], v[104:107], v[168:171]
    v_cvt_pk_bf16_f32 v195, v134, v135
    v_cvt_pk_bf16_f32 v196, v136, v137
    v_cvt_pk_bf16_f32 v197, v138, v139
    v_mfma_f32_16x16x32_bf16 v[164:167], v[112:115], v[108:111], v[164:167]
    v_cvt_pk_bf16_f32 v198, v140, v141
    v_cvt_pk_bf16_f32 v199, v142, v143
    v_permlane32_swap_b32 v192, v194
    v_mfma_f32_16x16x32_bf16 v[172:175], v[116:119], v[108:111], v[172:175]
    v_permlane32_swap_b32 v193, v195
    v_permlane32_swap_b32 v196, v198
    v_permlane32_swap_b32 v197, v199
    v_mfma_f32_16x16x32_bf16 v[176:179], v[120:123], v[104:107], v[176:179]
    v_cvt_pk_bf16_f32 v200, v144, v145
    v_cvt_pk_bf16_f32 v201, v146, v147
    v_cvt_pk_bf16_f32 v202, v148, v149
    v_mfma_f32_16x16x32_bf16 v[184:187], v[124:127], v[104:107], v[184:187]
    v_cvt_pk_bf16_f32 v203, v150, v151
    v_cvt_pk_bf16_f32 v204, v152, v153
    v_cvt_pk_bf16_f32 v205, v154, v155
    v_mfma_f32_16x16x32_bf16 v[180:183], v[120:123], v[108:111], v[180:183]
    v_cvt_pk_bf16_f32 v206, v156, v157
    v_cvt_pk_bf16_f32 v207, v158, v159
    v_permlane32_swap_b32 v200, v202
    v_mfma_f32_16x16x32_bf16 v[188:191], v[124:127], v[108:111], v[188:191]
    v_permlane32_swap_b32 v201, v203
    v_permlane32_swap_b32 v204, v206
    v_permlane32_swap_b32 v205, v207
    v_cvt_pk_bf16_f32 v208, v160, v161
    v_cvt_pk_bf16_f32 v209, v162, v163
    v_cvt_pk_bf16_f32 v210, v164, v165
    v_cvt_pk_bf16_f32 v211, v166, v167
    v_cvt_pk_bf16_f32 v212, v168, v169
    v_cvt_pk_bf16_f32 v213, v170, v171
    v_cvt_pk_bf16_f32 v214, v172, v173
    v_cvt_pk_bf16_f32 v215, v174, v175
    v_permlane32_swap_b32 v208, v210
    v_permlane32_swap_b32 v209, v211
    v_permlane32_swap_b32 v212, v214
    v_permlane32_swap_b32 v213, v215
    v_cvt_pk_bf16_f32 v216, v176, v177
    v_cvt_pk_bf16_f32 v217, v178, v179
    v_cvt_pk_bf16_f32 v218, v180, v181
    v_cvt_pk_bf16_f32 v219, v182, v183
    v_cvt_pk_bf16_f32 v220, v184, v185
    v_cvt_pk_bf16_f32 v221, v186, v187
    v_cvt_pk_bf16_f32 v222, v188, v189
    v_cvt_pk_bf16_f32 v223, v190, v191
    v_permlane32_swap_b32 v216, v218
    v_permlane32_swap_b32 v217, v219
    v_permlane32_swap_b32 v220, v222
    v_permlane32_swap_b32 v221, v223
KF_EN:
    s_mov_b32 s15, s67
    s_add_u32 s14, s14, 1
    s_cmp_eq_u32 s14, 1
    s_cbranch_scc1 KF_CS
    ds_write_b128 v2, v[192:195] offset:0
    ds_write_b128 v2, v[196:199] offset:1024
    ds_write_b128 v2, v[200:203] offset:8192
    ds_write_b128 v2, v[204:207] offset:9216
    ds_write_b128 v2, v[208:211] offset:2048
    ds_write_b128 v2, v[212:215] offset:3072
    ds_write_b128 v2, v[216:219] offset:10240
    ds_write_b128 v2, v[220:223] offset:11264
    s_waitcnt lgkmcnt(0)
KF_ATT:
    s_add_u32 s12, s92, 98304
    v_add_u32 v4, s12, v1
    s_barrier
    ds_read_b128 v[80:83], v249
    ds_read_b128 v[64:67], v4
    ds_read_b128 v[72:75], v4 offset:2048
    ds_read_b128 v[84:87], v249 offset:1024
    ds_read_b128 v[68:71], v4 offset:1024
    ds_read_b128 v[76:79], v4 offset:3072
    s_waitcnt lgkmcnt(4)
    v_mfma_f32_32x32x16_bf16 v[88:103], v[80:83], v[64:67], 0
    s_waitcnt lgkmcnt(3)
    v_mfma_f32_32x32x16_bf16 v[104:119], v[80:83], v[72:75], 0
    s_waitcnt lgkmcnt(1)
    v_mfma_f32_32x32x16_bf16 v[88:103], v[84:87], v[68:71], v[88:103]
    s_waitcnt lgkmcnt(0)
    v_mfma_f32_32x32x16_bf16 v[104:119], v[84:87], v[76:79], v[104:119]
    s_mov_b32 s10, 8
    s_nop 10
    v_max3_f32 v8, v88, v89, v90
    v_max3_f32 v8, v8, v91, v92
    v_max3_f32 v8, v8, v93, v94
    v_max3_f32 v8, v8, v95, v96
    v_max3_f32 v8, v8, v97, v98
    v_max3_f32 v8, v8, v99, v100
    v_max3_f32 v8, v8, v101, v102
    v_max_f32 v8, v8, v103
    v_max3_f32 v9, v104, v105, v106
    v_max3_f32 v9, v9, v107, v108
    v_max3_f32 v9, v9, v109, v110
    v_max3_f32 v9, v9, v111, v112
    v_max3_f32 v9, v9, v113, v114
    v_max3_f32 v9, v9, v115, v116
    v_max3_f32 v9, v9, v117, v118
    v_max_f32 v9, v9, v119
    v_mov_b32 v4, v8
    v_mov_b32 v5, v9
    s_nop 0
    v_permlane32_swap_b32 v8, v4
    v_permlane32_swap_b32 v9, v5
    s_nop 0
    v_max_f32 v8, v8, v4
    v_max_f32 v9, v9, v5
    v_min_f32 v8, v8, v9
    v_sub_f32 v120, 0, v8
    v_sub_f32 v121, 0, v8
    v_sub_f32 v122, 0, v8
    v_sub_f32 v123, 0, v8
    v_sub_f32 v124, 0, v8
    v_sub_f32 v125, 0, v8
    v_sub_f32 v126, 0, v8
    v_sub_f32 v127, 0, v8
    v_sub_f32 v128, 0, v8
    v_sub_f32 v129, 0, v8
    v_sub_f32 v130, 0, v8
    v_sub_f32 v131, 0, v8
    v_sub_f32 v132, 0, v8
    v_sub_f32 v133, 0, v8
    v_sub_f32 v134, 0, v8
    v_sub_f32 v135, 0, v8
    v_sub_f32 v88, v88, v8
    v_sub_f32 v89, v89, v8
    v_sub_f32 v90, v90, v8
    v_sub_f32 v91, v91, v8
    v_sub_f32 v92, v92, v8
    v_sub_f32 v93, v93, v8
    v_sub_f32 v94, v94, v8
    v_sub_f32 v95, v95, v8
    v_sub_f32 v96, v96, v8
    v_sub_f32 v97, v97, v8
    v_sub_f32 v98, v98, v8
    v_sub_f32 v99, v99, v8
    v_sub_f32 v100, v100, v8
    v_sub_f32 v101, v101, v8
    v_sub_f32 v102, v102, v8
    v_sub_f32 v103, v103, v8
    s_cmp_eq_u32 s5, 1
    s_cbranch_scc1 KF_AL1
.p2align 6
KF_AL0:
    v_mfma_f32_32x32x16_bf16 v[104:119], v[80:83], v[72:75], v[120:135]
    s_xor_b32 s22, s20, s21
    v_exp_f32 v88, v88
    v_exp_f32 v89, v89
    v_exp_f32 v90, v90
    v_exp_f32 v91, v91
    v_mfma_f32_32x32x16_bf16 v[104:119], v[84:87], v[76:79], v[104:119]
    ds_read_b128 v[80:83], v249 offset:4096
    v_cvt_pk_bf16_f32 v232, v88, v89
    v_exp_f32 v92, v92
    v_exp_f32 v93, v93
    v_cvt_pk_bf16_f32 v233, v90, v91
    v_exp_f32 v94, v94
    v_mfma_f32_32x32x16_bf16 v[36:51], v[224:227], v[240:243], v[36:51]
    ds_read_b128 v[84:87], v249 offset:5120
    v_exp_f32 v95, v95
    v_exp_f32 v96, v96
    v_cvt_pk_bf16_f32 v234, v92, v93
    v_exp_f32 v97, v97
    v_cvt_pk_bf16_f32 v235, v94, v95
    v_mfma_f32_32x32x16_bf16 v[36:51], v[228:231], v[244:247], v[36:51]
    ds_read_b128 v[224:227], v249 offset:2048
    v_exp_f32 v98, v98
    v_exp_f32 v99, v99
    v_cvt_pk_bf16_f32 v236, v96, v97
    v_exp_f32 v100, v100
    v_smfmac_f32_16x16x64_bf16 v[56:59], v[60:63], v[240:247], v248
    ds_read_b128 v[228:231], v249 offset:3072
    v_exp_f32 v101, v101
    v_cvt_pk_bf16_f32 v237, v98, v99
    v_exp_f32 v102, v102
    v_exp_f32 v103, v103
    v_cvt_pk_bf16_f32 v238, v100, v101
    v_cvt_pk_bf16_f32 v239, v102, v103
    s_waitcnt lgkmcnt(2)
    v_mfma_f32_32x32x16_bf16 v[88:103], v[80:83], v[64:67], v[120:135]
    s_setprio 0
    v_exp_f32 v104, v104
    v_exp_f32 v105, v105
    v_exp_f32 v106, v106
    v_exp_f32 v107, v107
    v_mfma_f32_32x32x16_bf16 v[88:103], v[84:87], v[68:71], v[88:103]
    s_waitcnt lgkmcnt(0)
    v_cvt_pk_bf16_f32 v240, v104, v105
    v_exp_f32 v108, v108
    v_exp_f32 v109, v109
    v_cvt_pk_bf16_f32 v241, v106, v107
    v_exp_f32 v110, v110
    v_mfma_f32_32x32x16_bf16 v[20:35], v[224:227], v[232:235], v[20:35]
    v_exp_f32 v111, v111
    v_exp_f32 v112, v112
    v_cvt_pk_bf16_f32 v242, v108, v109
    v_exp_f32 v113, v113
    v_cvt_pk_bf16_f32 v243, v110, v111
    v_mfma_f32_32x32x16_bf16 v[20:35], v[228:231], v[236:239], v[20:35]
    s_waitcnt vmcnt(4)
    v_exp_f32 v114, v114
    v_exp_f32 v115, v115
    v_cvt_pk_bf16_f32 v244, v112, v113
    v_exp_f32 v116, v116
    v_smfmac_f32_16x16x64_bf16 v[52:55], v[60:63], v[232:239], v248
    s_barrier
    s_setprio 1
    v_exp_f32 v117, v117
    v_cvt_pk_bf16_f32 v245, v114, v115
    v_exp_f32 v118, v118
    v_exp_f32 v119, v119
    v_cvt_pk_bf16_f32 v246, v116, v117
    v_cvt_pk_bf16_f32 v247, v118, v119
    v_mfma_f32_32x32x16_bf16 v[104:119], v[80:83], v[72:75], v[120:135]
    s_mov_b32 m0, s84
    v_exp_f32 v88, v88
    v_exp_f32 v89, v89
    v_exp_f32 v90, v90
    v_exp_f32 v91, v91
    v_mfma_f32_32x32x16_bf16 v[104:119], v[84:87], v[76:79], v[104:119]
    ds_read_b128 v[80:83], v249 offset:32768
    v_cvt_pk_bf16_f32 v232, v88, v89
    v_exp_f32 v92, v92
    v_exp_f32 v93, v93
    v_cvt_pk_bf16_f32 v233, v90, v91
    v_exp_f32 v94, v94
    v_mfma_f32_32x32x16_bf16 v[36:51], v[224:227], v[240:243], v[36:51]
    ds_read_b128 v[84:87], v249 offset:33792
    v_exp_f32 v95, v95
    v_exp_f32 v96, v96
    v_cvt_pk_bf16_f32 v234, v92, v93
    v_exp_f32 v97, v97
    v_cvt_pk_bf16_f32 v235, v94, v95
    v_mfma_f32_32x32x16_bf16 v[36:51], v[228:231], v[244:247], v[36:51]
    ds_read_b128 v[224:227], v249 offset:6144
    v_exp_f32 v98, v98
    v_exp_f32 v99, v99
    v_cvt_pk_bf16_f32 v236, v96, v97
    v_exp_f32 v100, v100
    v_smfmac_f32_16x16x64_bf16 v[56:59], v[60:63], v[240:247], v248
    ds_read_b128 v[228:231], v249 offset:7168
    v_exp_f32 v101, v101
    v_cvt_pk_bf16_f32 v237, v98, v99
    v_exp_f32 v102, v102
    v_exp_f32 v103, v103
    v_cvt_pk_bf16_f32 v238, v100, v101
    v_cvt_pk_bf16_f32 v239, v102, v103
    s_waitcnt lgkmcnt(2)
    v_mfma_f32_32x32x16_bf16 v[88:103], v[80:83], v[64:67], v[120:135]
    buffer_load_dwordx4 v1, s[80:83], s22 offen offset:0 sc1 lds
    v_exp_f32 v104, v104
    v_exp_f32 v105, v105
    v_exp_f32 v106, v106
    v_exp_f32 v107, v107
    v_mfma_f32_32x32x16_bf16 v[88:103], v[84:87], v[68:71], v[88:103]
    s_waitcnt lgkmcnt(0)
    v_cvt_pk_bf16_f32 v240, v104, v105
    v_exp_f32 v108, v108
    v_exp_f32 v109, v109
    v_cvt_pk_bf16_f32 v241, v106, v107
    v_exp_f32 v110, v110
    v_mfma_f32_32x32x16_bf16 v[20:35], v[224:227], v[232:235], v[20:35]
    buffer_load_dwordx4 v1, s[80:83], s22 offen offset:1024 sc1 lds
    v_exp_f32 v111, v111
    v_exp_f32 v112, v112
    v_cvt_pk_bf16_f32 v242, v108, v109
    v_exp_f32 v113, v113
    v_cvt_pk_bf16_f32 v243, v110, v111
    v_mfma_f32_32x32x16_bf16 v[20:35], v[228:231], v[236:239], v[20:35]
    buffer_load_dwordx4 v1, s[80:83], s22 offen offset:2048 sc1 lds
    v_exp_f32 v114, v114
    v_exp_f32 v115, v115
    v_cvt_pk_bf16_f32 v244, v112, v113
    v_exp_f32 v116, v116
    v_smfmac_f32_16x16x64_bf16 v[52:55], v[60:63], v[232:239], v248
    buffer_load_dwordx4 v1, s[80:83], s22 offen offset:3072 sc1 lds
    s_add_u32 s20, s20, 8192
    v_exp_f32 v117, v117
    v_cvt_pk_bf16_f32 v245, v114, v115
    v_exp_f32 v118, v118
    v_exp_f32 v119, v119
    v_cvt_pk_bf16_f32 v246, v116, v117
    v_cvt_pk_bf16_f32 v247, v118, v119
    v_mfma_f32_32x32x16_bf16 v[104:119], v[80:83], v[72:75], v[120:135]
    s_xor_b32 s22, s20, s21
    v_exp_f32 v88, v88
    v_exp_f32 v89, v89
    v_exp_f32 v90, v90
    v_exp_f32 v91, v91
    v_mfma_f32_32x32x16_bf16 v[104:119], v[84:87], v[76:79], v[104:119]
    ds_read_b128 v[80:83], v249 offset:36864
    v_cvt_pk_bf16_f32 v232, v88, v89
    v_exp_f32 v92, v92
    v_exp_f32 v93, v93
    v_cvt_pk_bf16_f32 v233, v90, v91
    v_exp_f32 v94, v94
    v_mfma_f32_32x32x16_bf16 v[36:51], v[224:227], v[240:243], v[36:51]
    ds_read_b128 v[84:87], v249 offset:37888
    v_exp_f32 v95, v95
    v_exp_f32 v96, v96
    v_cvt_pk_bf16_f32 v234, v92, v93
    v_exp_f32 v97, v97
    v_cvt_pk_bf16_f32 v235, v94, v95
    v_mfma_f32_32x32x16_bf16 v[36:51], v[228:231], v[244:247], v[36:51]
    ds_read_b128 v[224:227], v249 offset:34816
    v_exp_f32 v98, v98
    v_exp_f32 v99, v99
    v_cvt_pk_bf16_f32 v236, v96, v97
    v_exp_f32 v100, v100
    v_smfmac_f32_16x16x64_bf16 v[56:59], v[60:63], v[240:247], v248
    ds_read_b128 v[228:231], v249 offset:35840
    v_exp_f32 v101, v101
    v_cvt_pk_bf16_f32 v237, v98, v99
    v_exp_f32 v102, v102
    v_exp_f32 v103, v103
    v_cvt_pk_bf16_f32 v238, v100, v101
    v_cvt_pk_bf16_f32 v239, v102, v103
    s_waitcnt lgkmcnt(2)
    v_mfma_f32_32x32x16_bf16 v[88:103], v[80:83], v[64:67], v[120:135]
    s_setprio 0
    v_exp_f32 v104, v104
    v_exp_f32 v105, v105
    v_exp_f32 v106, v106
    v_exp_f32 v107, v107
    v_mfma_f32_32x32x16_bf16 v[88:103], v[84:87], v[68:71], v[88:103]
    s_waitcnt lgkmcnt(0)
    v_cvt_pk_bf16_f32 v240, v104, v105
    v_exp_f32 v108, v108
    v_exp_f32 v109, v109
    v_cvt_pk_bf16_f32 v241, v106, v107
    v_exp_f32 v110, v110
    v_mfma_f32_32x32x16_bf16 v[20:35], v[224:227], v[232:235], v[20:35]
    v_exp_f32 v111, v111
    v_exp_f32 v112, v112
    v_cvt_pk_bf16_f32 v242, v108, v109
    v_exp_f32 v113, v113
    v_cvt_pk_bf16_f32 v243, v110, v111
    v_mfma_f32_32x32x16_bf16 v[20:35], v[228:231], v[236:239], v[20:35]
    s_waitcnt vmcnt(4)
    v_exp_f32 v114, v114
    v_exp_f32 v115, v115
    v_cvt_pk_bf16_f32 v244, v112, v113
    v_exp_f32 v116, v116
    v_smfmac_f32_16x16x64_bf16 v[52:55], v[60:63], v[232:239], v248
    s_barrier
    s_setprio 1
    v_exp_f32 v117, v117
    v_cvt_pk_bf16_f32 v245, v114, v115
    v_exp_f32 v118, v118
    v_exp_f32 v119, v119
    v_cvt_pk_bf16_f32 v246, v116, v117
    v_cvt_pk_bf16_f32 v247, v118, v119
    v_mfma_f32_32x32x16_bf16 v[104:119], v[80:83], v[72:75], v[120:135]
    s_mov_b32 m0, s85
    v_exp_f32 v88, v88
    v_exp_f32 v89, v89
    v_exp_f32 v90, v90
    v_exp_f32 v91, v91
    v_mfma_f32_32x32x16_bf16 v[104:119], v[84:87], v[76:79], v[104:119]
    ds_read_b128 v[80:83], v254 offset:0
    v_cvt_pk_bf16_f32 v232, v88, v89
    v_exp_f32 v92, v92
    v_exp_f32 v93, v93
    v_cvt_pk_bf16_f32 v233, v90, v91
    v_exp_f32 v94, v94
    v_mfma_f32_32x32x16_bf16 v[36:51], v[224:227], v[240:243], v[36:51]
    ds_read_b128 v[84:87], v254 offset:1024
    v_exp_f32 v95, v95
    v_exp_f32 v96, v96
    v_cvt_pk_bf16_f32 v234, v92, v93
    v_exp_f32 v97, v97
    v_cvt_pk_bf16_f32 v235, v94, v95
    v_mfma_f32_32x32x16_bf16 v[36:51], v[228:231], v[244:247], v[36:51]
    ds_read_b128 v[224:227], v249 offset:38912
    v_exp_f32 v98, v98
    v_exp_f32 v99, v99
    v_cvt_pk_bf16_f32 v236, v96, v97
    v_exp_f32 v100, v100
    v_smfmac_f32_16x16x64_bf16 v[56:59], v[60:63], v[240:247], v248
    ds_read_b128 v[228:231], v249 offset:39936
    v_exp_f32 v101, v101
    v_cvt_pk_bf16_f32 v237, v98, v99
    v_exp_f32 v102, v102
    v_exp_f32 v103, v103
    v_cvt_pk_bf16_f32 v238, v100, v101
    v_cvt_pk_bf16_f32 v239, v102, v103
    s_waitcnt lgkmcnt(2)
    v_mfma_f32_32x32x16_bf16 v[88:103], v[80:83], v[64:67], v[120:135]
    buffer_load_dwordx4 v1, s[80:83], s22 offen offset:0 sc1 lds
    v_exp_f32 v104, v104
    v_exp_f32 v105, v105
    v_exp_f32 v106, v106
    v_exp_f32 v107, v107
    v_mfma_f32_32x32x16_bf16 v[88:103], v[84:87], v[68:71], v[88:103]
    s_waitcnt lgkmcnt(0)
    v_cvt_pk_bf16_f32 v240, v104, v105
    v_exp_f32 v108, v108
    v_exp_f32 v109, v109
    v_cvt_pk_bf16_f32 v241, v106, v107
    v_exp_f32 v110, v110
    v_mfma_f32_32x32x16_bf16 v[20:35], v[224:227], v[232:235], v[20:35]
    buffer_load_dwordx4 v1, s[80:83], s22 offen offset:1024 sc1 lds
    v_exp_f32 v111, v111
    v_exp_f32 v112, v112
    v_cvt_pk_bf16_f32 v242, v108, v109
    v_exp_f32 v113, v113
    v_cvt_pk_bf16_f32 v243, v110, v111
    v_mfma_f32_32x32x16_bf16 v[20:35], v[228:231], v[236:239], v[20:35]
    buffer_load_dwordx4 v1, s[80:83], s22 offen offset:2048 sc1 lds
    v_exp_f32 v114, v114
    v_exp_f32 v115, v115
    v_cvt_pk_bf16_f32 v244, v112, v113
    v_exp_f32 v116, v116
    v_smfmac_f32_16x16x64_bf16 v[52:55], v[60:63], v[232:239], v248
    buffer_load_dwordx4 v1, s[80:83], s22 offen offset:3072 sc1 lds
    s_add_u32 s20, s20, 8192
    v_exp_f32 v117, v117
    v_cvt_pk_bf16_f32 v245, v114, v115
    v_exp_f32 v118, v118
    v_exp_f32 v119, v119
    v_cvt_pk_bf16_f32 v246, v116, v117
    v_cvt_pk_bf16_f32 v247, v118, v119
    v_mfma_f32_32x32x16_bf16 v[104:119], v[80:83], v[72:75], v[120:135]
    s_xor_b32 s22, s20, s21
    v_exp_f32 v88, v88
    v_exp_f32 v89, v89
    v_exp_f32 v90, v90
    v_exp_f32 v91, v91
    v_mfma_f32_32x32x16_bf16 v[104:119], v[84:87], v[76:79], v[104:119]
    ds_read_b128 v[80:83], v254 offset:4096
    v_cvt_pk_bf16_f32 v232, v88, v89
    v_exp_f32 v92, v92
    v_exp_f32 v93, v93
    v_cvt_pk_bf16_f32 v233, v90, v91
    v_exp_f32 v94, v94
    v_mfma_f32_32x32x16_bf16 v[36:51], v[224:227], v[240:243], v[36:51]
    ds_read_b128 v[84:87], v254 offset:5120
    v_exp_f32 v95, v95
    v_exp_f32 v96, v96
    v_cvt_pk_bf16_f32 v234, v92, v93
    v_exp_f32 v97, v97
    v_cvt_pk_bf16_f32 v235, v94, v95
    v_mfma_f32_32x32x16_bf16 v[36:51], v[228:231], v[244:247], v[36:51]
    ds_read_b128 v[224:227], v254 offset:2048
    v_exp_f32 v98, v98
    v_exp_f32 v99, v99
    v_cvt_pk_bf16_f32 v236, v96, v97
    v_exp_f32 v100, v100
    v_smfmac_f32_16x16x64_bf16 v[56:59], v[60:63], v[240:247], v248
    ds_read_b128 v[228:231], v254 offset:3072
    v_exp_f32 v101, v101
    v_cvt_pk_bf16_f32 v237, v98, v99
    v_exp_f32 v102, v102
    v_exp_f32 v103, v103
    v_cvt_pk_bf16_f32 v238, v100, v101
    v_cvt_pk_bf16_f32 v239, v102, v103
    s_waitcnt lgkmcnt(2)
    v_mfma_f32_32x32x16_bf16 v[88:103], v[80:83], v[64:67], v[120:135]
    s_setprio 0
    v_exp_f32 v104, v104
    v_exp_f32 v105, v105
    v_exp_f32 v106, v106
    v_exp_f32 v107, v107
    v_mfma_f32_32x32x16_bf16 v[88:103], v[84:87], v[68:71], v[88:103]
    s_waitcnt lgkmcnt(0)
    v_cvt_pk_bf16_f32 v240, v104, v105
    v_exp_f32 v108, v108
    v_exp_f32 v109, v109
    v_cvt_pk_bf16_f32 v241, v106, v107
    v_exp_f32 v110, v110
    v_mfma_f32_32x32x16_bf16 v[20:35], v[224:227], v[232:235], v[20:35]
    v_exp_f32 v111, v111
    v_exp_f32 v112, v112
    v_cvt_pk_bf16_f32 v242, v108, v109
    v_exp_f32 v113, v113
    v_cvt_pk_bf16_f32 v243, v110, v111
    v_mfma_f32_32x32x16_bf16 v[20:35], v[228:231], v[236:239], v[20:35]
    s_waitcnt vmcnt(4)
    v_exp_f32 v114, v114
    v_exp_f32 v115, v115
    v_cvt_pk_bf16_f32 v244, v112, v113
    v_exp_f32 v116, v116
    v_smfmac_f32_16x16x64_bf16 v[52:55], v[60:63], v[232:239], v248
    s_barrier
    s_setprio 1
    v_exp_f32 v117, v117
    v_cvt_pk_bf16_f32 v245, v114, v115
    v_exp_f32 v118, v118
    v_exp_f32 v119, v119
    v_cvt_pk_bf16_f32 v246, v116, v117
    v_cvt_pk_bf16_f32 v247, v118, v119
    v_mfma_f32_32x32x16_bf16 v[104:119], v[80:83], v[72:75], v[120:135]
    s_mov_b32 m0, s86
    v_exp_f32 v88, v88
    v_exp_f32 v89, v89
    v_exp_f32 v90, v90
    v_exp_f32 v91, v91
    v_mfma_f32_32x32x16_bf16 v[104:119], v[84:87], v[76:79], v[104:119]
    ds_read_b128 v[80:83], v254 offset:32768
    v_cvt_pk_bf16_f32 v232, v88, v89
    v_exp_f32 v92, v92
    v_exp_f32 v93, v93
    v_cvt_pk_bf16_f32 v233, v90, v91
    v_exp_f32 v94, v94
    v_mfma_f32_32x32x16_bf16 v[36:51], v[224:227], v[240:243], v[36:51]
    ds_read_b128 v[84:87], v254 offset:33792
    v_exp_f32 v95, v95
    v_exp_f32 v96, v96
    v_cvt_pk_bf16_f32 v234, v92, v93
    v_exp_f32 v97, v97
    v_cvt_pk_bf16_f32 v235, v94, v95
    v_mfma_f32_32x32x16_bf16 v[36:51], v[228:231], v[244:247], v[36:51]
    ds_read_b128 v[224:227], v254 offset:6144
    v_exp_f32 v98, v98
    v_exp_f32 v99, v99
    v_cvt_pk_bf16_f32 v236, v96, v97
    v_exp_f32 v100, v100
    v_smfmac_f32_16x16x64_bf16 v[56:59], v[60:63], v[240:247], v248
    ds_read_b128 v[228:231], v254 offset:7168
    v_exp_f32 v101, v101
    v_cvt_pk_bf16_f32 v237, v98, v99
    v_exp_f32 v102, v102
    v_exp_f32 v103, v103
    v_cvt_pk_bf16_f32 v238, v100, v101
    v_cvt_pk_bf16_f32 v239, v102, v103
    s_waitcnt lgkmcnt(2)
    v_mfma_f32_32x32x16_bf16 v[88:103], v[80:83], v[64:67], v[120:135]
    buffer_load_dwordx4 v1, s[80:83], s22 offen offset:0 sc1 lds
    v_exp_f32 v104, v104
    v_exp_f32 v105, v105
    v_exp_f32 v106, v106
    v_exp_f32 v107, v107
    v_mfma_f32_32x32x16_bf16 v[88:103], v[84:87], v[68:71], v[88:103]
    s_waitcnt lgkmcnt(0)
    v_cvt_pk_bf16_f32 v240, v104, v105
    v_exp_f32 v108, v108
    v_exp_f32 v109, v109
    v_cvt_pk_bf16_f32 v241, v106, v107
    v_exp_f32 v110, v110
    v_mfma_f32_32x32x16_bf16 v[20:35], v[224:227], v[232:235], v[20:35]
    buffer_load_dwordx4 v1, s[80:83], s22 offen offset:1024 sc1 lds
    v_exp_f32 v111, v111
    v_exp_f32 v112, v112
    v_cvt_pk_bf16_f32 v242, v108, v109
    v_exp_f32 v113, v113
    v_cvt_pk_bf16_f32 v243, v110, v111
    v_mfma_f32_32x32x16_bf16 v[20:35], v[228:231], v[236:239], v[20:35]
    buffer_load_dwordx4 v1, s[80:83], s22 offen offset:2048 sc1 lds
    v_exp_f32 v114, v114
    v_exp_f32 v115, v115
    v_cvt_pk_bf16_f32 v244, v112, v113
    v_exp_f32 v116, v116
    v_smfmac_f32_16x16x64_bf16 v[52:55], v[60:63], v[232:239], v248
    buffer_load_dwordx4 v1, s[80:83], s22 offen offset:3072 sc1 lds
    s_add_u32 s20, s20, 8192
    v_exp_f32 v117, v117
    v_cvt_pk_bf16_f32 v245, v114, v115
    v_exp_f32 v118, v118
    v_exp_f32 v119, v119
    v_cvt_pk_bf16_f32 v246, v116, v117
    v_cvt_pk_bf16_f32 v247, v118, v119
    v_mfma_f32_32x32x16_bf16 v[104:119], v[80:83], v[72:75], v[120:135]
    s_xor_b32 s22, s20, s21
    v_exp_f32 v88, v88
    v_exp_f32 v89, v89
    v_exp_f32 v90, v90
    v_exp_f32 v91, v91
    v_mfma_f32_32x32x16_bf16 v[104:119], v[84:87], v[76:79], v[104:119]
    ds_read_b128 v[80:83], v254 offset:36864
    v_cvt_pk_bf16_f32 v232, v88, v89
    v_exp_f32 v92, v92
    v_exp_f32 v93, v93
    v_cvt_pk_bf16_f32 v233, v90, v91
    v_exp_f32 v94, v94
    v_mfma_f32_32x32x16_bf16 v[36:51], v[224:227], v[240:243], v[36:51]
    ds_read_b128 v[84:87], v254 offset:37888
    v_exp_f32 v95, v95
    v_exp_f32 v96, v96
    v_cvt_pk_bf16_f32 v234, v92, v93
    v_exp_f32 v97, v97
    v_cvt_pk_bf16_f32 v235, v94, v95
    v_mfma_f32_32x32x16_bf16 v[36:51], v[228:231], v[244:247], v[36:51]
    ds_read_b128 v[224:227], v254 offset:34816
    v_exp_f32 v98, v98
    v_exp_f32 v99, v99
    v_cvt_pk_bf16_f32 v236, v96, v97
    v_exp_f32 v100, v100
    v_smfmac_f32_16x16x64_bf16 v[56:59], v[60:63], v[240:247], v248
    ds_read_b128 v[228:231], v254 offset:35840
    v_exp_f32 v101, v101
    v_cvt_pk_bf16_f32 v237, v98, v99
    v_exp_f32 v102, v102
    v_exp_f32 v103, v103
    v_cvt_pk_bf16_f32 v238, v100, v101
    v_cvt_pk_bf16_f32 v239, v102, v103
    s_waitcnt lgkmcnt(2)
    v_mfma_f32_32x32x16_bf16 v[88:103], v[80:83], v[64:67], v[120:135]
    s_setprio 0
    v_exp_f32 v104, v104
    v_exp_f32 v105, v105
    v_exp_f32 v106, v106
    v_exp_f32 v107, v107
    v_mfma_f32_32x32x16_bf16 v[88:103], v[84:87], v[68:71], v[88:103]
    s_waitcnt lgkmcnt(0)
    v_cvt_pk_bf16_f32 v240, v104, v105
    v_exp_f32 v108, v108
    v_exp_f32 v109, v109
    v_cvt_pk_bf16_f32 v241, v106, v107
    v_exp_f32 v110, v110
    v_mfma_f32_32x32x16_bf16 v[20:35], v[224:227], v[232:235], v[20:35]
    s_sub_u32 s10, s10, 1
    v_exp_f32 v111, v111
    v_exp_f32 v112, v112
    v_cvt_pk_bf16_f32 v242, v108, v109
    v_exp_f32 v113, v113
    v_cvt_pk_bf16_f32 v243, v110, v111
    v_mfma_f32_32x32x16_bf16 v[20:35], v[228:231], v[236:239], v[20:35]
    s_waitcnt vmcnt(4)
    v_exp_f32 v114, v114
    v_exp_f32 v115, v115
    v_cvt_pk_bf16_f32 v244, v112, v113
    v_exp_f32 v116, v116
    v_smfmac_f32_16x16x64_bf16 v[52:55], v[60:63], v[232:239], v248
    s_barrier
    s_setprio 1
    v_exp_f32 v117, v117
    v_cvt_pk_bf16_f32 v245, v114, v115
    v_exp_f32 v118, v118
    v_exp_f32 v119, v119
    v_cvt_pk_bf16_f32 v246, v116, v117
    v_cvt_pk_bf16_f32 v247, v118, v119
    v_mfma_f32_32x32x16_bf16 v[104:119], v[80:83], v[72:75], v[120:135]
    s_mov_b32 m0, s87
    v_exp_f32 v88, v88
    v_exp_f32 v89, v89
    v_exp_f32 v90, v90
    v_exp_f32 v91, v91
    v_mfma_f32_32x32x16_bf16 v[104:119], v[84:87], v[76:79], v[104:119]
    ds_read_b128 v[80:83], v249 offset:0
    v_cvt_pk_bf16_f32 v232, v88, v89
    v_exp_f32 v92, v92
    v_exp_f32 v93, v93
    v_cvt_pk_bf16_f32 v233, v90, v91
    v_exp_f32 v94, v94
    v_mfma_f32_32x32x16_bf16 v[36:51], v[224:227], v[240:243], v[36:51]
    ds_read_b128 v[84:87], v249 offset:1024
    v_exp_f32 v95, v95
    v_exp_f32 v96, v96
    v_cvt_pk_bf16_f32 v234, v92, v93
    v_exp_f32 v97, v97
    v_cvt_pk_bf16_f32 v235, v94, v95
    v_mfma_f32_32x32x16_bf16 v[36:51], v[228:231], v[244:247], v[36:51]
    ds_read_b128 v[224:227], v254 offset:38912
    v_exp_f32 v98, v98
    v_exp_f32 v99, v99
    v_cvt_pk_bf16_f32 v236, v96, v97
    v_exp_f32 v100, v100
    v_smfmac_f32_16x16x64_bf16 v[56:59], v[60:63], v[240:247], v248
    ds_read_b128 v[228:231], v254 offset:39936
    v_exp_f32 v101, v101
    v_cvt_pk_bf16_f32 v237, v98, v99
    v_exp_f32 v102, v102
    v_exp_f32 v103, v103
    v_cvt_pk_bf16_f32 v238, v100, v101
    v_cvt_pk_bf16_f32 v239, v102, v103
    s_waitcnt lgkmcnt(2)
    v_mfma_f32_32x32x16_bf16 v[88:103], v[80:83], v[64:67], v[120:135]
    buffer_load_dwordx4 v1, s[80:83], s22 offen offset:0 sc1 lds
    v_exp_f32 v104, v104
    v_exp_f32 v105, v105
    v_exp_f32 v106, v106
    v_exp_f32 v107, v107
    v_mfma_f32_32x32x16_bf16 v[88:103], v[84:87], v[68:71], v[88:103]
    s_waitcnt lgkmcnt(0)
    v_cvt_pk_bf16_f32 v240, v104, v105
    v_exp_f32 v108, v108
    v_exp_f32 v109, v109
    v_cvt_pk_bf16_f32 v241, v106, v107
    v_exp_f32 v110, v110
    v_mfma_f32_32x32x16_bf16 v[20:35], v[224:227], v[232:235], v[20:35]
    buffer_load_dwordx4 v1, s[80:83], s22 offen offset:1024 sc1 lds
    v_exp_f32 v111, v111
    v_exp_f32 v112, v112
    v_cvt_pk_bf16_f32 v242, v108, v109
    v_exp_f32 v113, v113
    v_cvt_pk_bf16_f32 v243, v110, v111
    v_mfma_f32_32x32x16_bf16 v[20:35], v[228:231], v[236:239], v[20:35]
    buffer_load_dwordx4 v1, s[80:83], s22 offen offset:2048 sc1 lds
    v_exp_f32 v114, v114
    v_exp_f32 v115, v115
    v_cvt_pk_bf16_f32 v244, v112, v113
    v_exp_f32 v116, v116
    v_smfmac_f32_16x16x64_bf16 v[52:55], v[60:63], v[232:239], v248
    buffer_load_dwordx4 v1, s[80:83], s22 offen offset:3072 sc1 lds
    s_add_u32 s20, s20, 8192
    v_exp_f32 v117, v117
    v_cvt_pk_bf16_f32 v245, v114, v115
    v_exp_f32 v118, v118
    v_exp_f32 v119, v119
    v_cvt_pk_bf16_f32 v246, v116, v117
    v_cvt_pk_bf16_f32 v247, v118, v119
    s_cmp_lg_u32 s10, 0
    s_cbranch_scc0 KF_AD
    s_lshr_b32 s11, 98, s10
    s_bitcmp1_b32 s11, 0
    s_cbranch_scc0 KF_AL0
    s_cmp_eq_u32 s10, 1
    s_cbranch_scc1 KF_HL0
    s_lshl_b32 s11, s3, 2
    s_add_u32 s11, s11, 192
    v_mov_b32 v6, s11
    s_cmp_eq_u32 s10, 5
    s_cbranch_scc1 KF_HC
    buffer_load_dword v5, v6, s[60:63], 0 offen sc0 sc1
    s_branch KF_AL0
KF_HC:
    v_cmp_gt_u32 vcc, 16, v5
    s_mov_b32 s12, 0
    s_nop 1
    s_cbranch_vccz KF_AL0
KF_P2:
    buffer_load_dword v5, v6, s[60:63], 0 offen sc0 sc1
    s_add_u32 s12, s12, 1
    s_waitcnt vmcnt(0)
    v_cmp_gt_u32 vcc, 16, v5
    s_cmp_gt_u32 s12, 0x40000
    s_cbranch_scc1 KF_AL0
    s_cbranch_vccnz KF_P2
    s_branch KF_AL0
KF_HL0:
    s_mov_b32 s85, 131072
    s_mov_b32 s86, 131072
    s_mov_b32 s87, 131072
    s_and_b32 s11, s6, 7
    s_lshl_b32 s11, s11, 3
    s_add_u32 s11, s11, s8
    s_lshl_b32 s11, s11, 15
    s_lshl_b32 s12, s3, 8
    s_add_u32 s11, s11, s12
    v_lshrrev_b32 v5, 4, v0
    v_and_b32 v6, 15, v0
    v_lshlrev_b32 v6, 4, v6
    v_lshl_add_u32 v5, v5, 11, v6
    buffer_load_dwordx4 v[250:253], v5, s[24:27], s11 offen
    s_add_u32 s11, s11, 8192
    buffer_load_dwordx4 v[250:253], v5, s[24:27], s11 offen
    s_add_u32 s11, s11, 8192
    buffer_load_dwordx4 v[250:253], v5, s[24:27], s11 offen
    s_add_u32 s11, s11, 8192
    buffer_load_dwordx4 v[250:253], v5, s[24:27], s11 offen
    s_add_u32 s11, s11, 8192
    s_lshl_b32 s11, s8, 10
    s_add_u32 s11, s11, KF_AD - KF_PC
    buffer_load_dwordx4 v[250:253], v1, s[76:79], s11 offen
    s_add_u32 s11, s11, 8192
    buffer_load_dwordx4 v[250:253], v1, s[76:79], s11 offen
    s_add_u32 s11, s11, 8192
    s_and_b32 s13, s8, 3
    v_lshrrev_b32 v5, 4, v0
    v_lshrrev_b32 v6, 1, v0
    v_and_b32 v6, 7, v6
    v_xor_b32 v6, v6, v5
    v_lshlrev_b32 v6, 5, v6
    v_and_b32 v7, 1, v0
    v_lshl_add_u32 v6, v7, 4, v6
    v_lshl_add_u32 v10, v5, 11, v6
    v_xor_b32 v11, 128, v10
    s_lshl_b32 s70, s13, 15
    s_lshl_b32 s11, s3, 8
    s_add_u32 s70, s70, s11
    s_lshl_b32 s71, s13, 12
    s_mov_b32 s75, 2
    s_lshr_b32 s11, s88, 1
    s_lshl_b32 s11, s11, 15
    s_lshl_b32 s12, s89, 13
    s_add_u32 s11, s11, s12
    s_and_b32 s12, s88, 1
    s_lshl_b32 s12, s12, 11
    s_add_u32 s11, s11, s12
    v_add_u32 v13, s11, v1
    v_lshrrev_b32 v14, 3, v0
    v_and_b32 v12, 7, v0
    v_lshlrev_b32 v12, 2, v12
    v_lshl_add_u32 v14, v14, 7, v12
    s_lshl_b32 s11, s3, 5
    s_add_u32 s11, s11, s8
    s_lshl_b32 s11, s11, 2
    v_mov_b32 v12, s11
    s_add_u32 s69, s94, 12582912
    s_branch KF_AL0
.p2align 6
KF_AL1:
    v_mfma_f32_32x32x16_bf16 v[104:119], v[80:83], v[72:75], v[120:135]
    v_exp_f32 v88, v88
    v_exp_f32 v89, v89
    v_exp_f32 v90, v90
    v_exp_f32 v91, v91
    v_mfma_f32_32x32x16_bf16 v[104:119], v[84:87], v[76:79], v[104:119]
    ds_read_b128 v[80:83], v249 offset:4096
    v_cvt_pk_bf16_f32 v232, v88, v89
    v_exp_f32 v92, v92
    v_exp_f32 v93, v93
    v_cvt_pk_bf16_f32 v233, v90, v91
    v_exp_f32 v94, v94
    v_mfma_f32_32x32x16_bf16 v[36:51], v[224:227], v[240:243], v[36:51]
    ds_read_b128 v[84:87], v249 offset:5120
    v_exp_f32 v95, v95
    v_exp_f32 v96, v96
    v_cvt_pk_bf16_f32 v234, v92, v93
    v_exp_f32 v97, v97
    v_cvt_pk_bf16_f32 v235, v94, v95
    v_mfma_f32_32x32x16_bf16 v[36:51], v[228:231], v[244:247], v[36:51]
    ds_read_b128 v[224:227], v249 offset:2048
    v_exp_f32 v98, v98
    v_exp_f32 v99, v99
    v_cvt_pk_bf16_f32 v236, v96, v97
    v_exp_f32 v100, v100
    v_smfmac_f32_16x16x64_bf16 v[56:59], v[60:63], v[240:247], v248
    ds_read_b128 v[228:231], v249 offset:3072
    v_exp_f32 v101, v101
    v_cvt_pk_bf16_f32 v237, v98, v99
    v_exp_f32 v102, v102
    v_exp_f32 v103, v103
    v_cvt_pk_bf16_f32 v238, v100, v101
    v_cvt_pk_bf16_f32 v239, v102, v103
    s_waitcnt lgkmcnt(2)
    v_mfma_f32_32x32x16_bf16 v[88:103], v[80:83], v[64:67], v[120:135]
    s_setprio 0
    v_exp_f32 v104, v104
    v_exp_f32 v105, v105
    v_exp_f32 v106, v106
    v_exp_f32 v107, v107
    v_mfma_f32_32x32x16_bf16 v[88:103], v[84:87], v[68:71], v[88:103]
    s_waitcnt lgkmcnt(0)
    v_cvt_pk_bf16_f32 v240, v104, v105
    v_exp_f32 v108, v108
    v_exp_f32 v109, v109
    v_cvt_pk_bf16_f32 v241, v106, v107
    v_exp_f32 v110, v110
    v_mfma_f32_32x32x16_bf16 v[20:35], v[224:227], v[232:235], v[20:35]
    v_exp_f32 v111, v111
    v_exp_f32 v112, v112
    v_cvt_pk_bf16_f32 v242, v108, v109
    v_exp_f32 v113, v113
    v_cvt_pk_bf16_f32 v243, v110, v111
    v_mfma_f32_32x32x16_bf16 v[20:35], v[228:231], v[236:239], v[20:35]
    s_waitcnt vmcnt(1)
    v_exp_f32 v114, v114
    v_exp_f32 v115, v115
    v_cvt_pk_bf16_f32 v244, v112, v113
    v_exp_f32 v116, v116
    v_smfmac_f32_16x16x64_bf16 v[52:55], v[60:63], v[232:239], v248
    s_barrier
    s_setprio 1
    v_exp_f32 v117, v117
    v_cvt_pk_bf16_f32 v245, v114, v115
    v_exp_f32 v118, v118
    v_exp_f32 v119, v119
    v_cvt_pk_bf16_f32 v246, v116, v117
    v_cvt_pk_bf16_f32 v247, v118, v119
    v_mfma_f32_32x32x16_bf16 v[104:119], v[80:83], v[72:75], v[120:135]
    s_mov_b32 m0, s84
    v_exp_f32 v88, v88
    v_exp_f32 v89, v89
    v_exp_f32 v90, v90
    v_exp_f32 v91, v91
    v_mfma_f32_32x32x16_bf16 v[104:119], v[84:87], v[76:79], v[104:119]
    ds_read_b128 v[80:83], v249 offset:32768
    v_cvt_pk_bf16_f32 v232, v88, v89
    v_exp_f32 v92, v92
    v_exp_f32 v93, v93
    v_cvt_pk_bf16_f32 v233, v90, v91
    v_exp_f32 v94, v94
    v_mfma_f32_32x32x16_bf16 v[36:51], v[224:227], v[240:243], v[36:51]
    ds_read_b128 v[84:87], v249 offset:33792
    v_exp_f32 v95, v95
    v_exp_f32 v96, v96
    v_cvt_pk_bf16_f32 v234, v92, v93
    v_exp_f32 v97, v97
    v_cvt_pk_bf16_f32 v235, v94, v95
    v_mfma_f32_32x32x16_bf16 v[36:51], v[228:231], v[244:247], v[36:51]
    ds_read_b128 v[224:227], v249 offset:6144
    v_exp_f32 v98, v98
    v_exp_f32 v99, v99
    v_cvt_pk_bf16_f32 v236, v96, v97
    v_exp_f32 v100, v100
    v_smfmac_f32_16x16x64_bf16 v[56:59], v[60:63], v[240:247], v248
    ds_read_b128 v[228:231], v249 offset:7168
    v_exp_f32 v101, v101
    v_cvt_pk_bf16_f32 v237, v98, v99
    v_exp_f32 v102, v102
    v_exp_f32 v103, v103
    v_cvt_pk_bf16_f32 v238, v100, v101
    v_cvt_pk_bf16_f32 v239, v102, v103
    s_waitcnt lgkmcnt(2)
    v_mfma_f32_32x32x16_bf16 v[88:103], v[80:83], v[64:67], v[120:135]
    v_exp_f32 v104, v104
    v_exp_f32 v105, v105
    v_exp_f32 v106, v106
    v_exp_f32 v107, v107
    v_mfma_f32_32x32x16_bf16 v[88:103], v[84:87], v[68:71], v[88:103]
    s_waitcnt lgkmcnt(0)
    v_cvt_pk_bf16_f32 v240, v104, v105
    v_exp_f32 v108, v108
    v_exp_f32 v109, v109
    v_cvt_pk_bf16_f32 v241, v106, v107
    v_exp_f32 v110, v110
    v_mfma_f32_32x32x16_bf16 v[20:35], v[224:227], v[232:235], v[20:35]
    buffer_load_dwordx4 v1, s[80:83], s20 offen offset:0 sc1 lds
    v_exp_f32 v111, v111
    v_exp_f32 v112, v112
    v_cvt_pk_bf16_f32 v242, v108, v109
    v_exp_f32 v113, v113
    v_cvt_pk_bf16_f32 v243, v110, v111
    v_mfma_f32_32x32x16_bf16 v[20:35], v[228:231], v[236:239], v[20:35]
    v_exp_f32 v114, v114
    v_exp_f32 v115, v115
    v_cvt_pk_bf16_f32 v244, v112, v113
    v_exp_f32 v116, v116
    v_smfmac_f32_16x16x64_bf16 v[52:55], v[60:63], v[232:239], v248
    s_add_u32 s20, s20, 8192
    v_exp_f32 v117, v117
    v_cvt_pk_bf16_f32 v245, v114, v115
    v_exp_f32 v118, v118
    v_exp_f32 v119, v119
    v_cvt_pk_bf16_f32 v246, v116, v117
    v_cvt_pk_bf16_f32 v247, v118, v119
    v_mfma_f32_32x32x16_bf16 v[104:119], v[80:83], v[72:75], v[120:135]
    v_exp_f32 v88, v88
    v_exp_f32 v89, v89
    v_exp_f32 v90, v90
    v_exp_f32 v91, v91
    v_mfma_f32_32x32x16_bf16 v[104:119], v[84:87], v[76:79], v[104:119]
    ds_read_b128 v[80:83], v249 offset:36864
    v_cvt_pk_bf16_f32 v232, v88, v89
    v_exp_f32 v92, v92
    v_exp_f32 v93, v93
    v_cvt_pk_bf16_f32 v233, v90, v91
    v_exp_f32 v94, v94
    v_mfma_f32_32x32x16_bf16 v[36:51], v[224:227], v[240:243], v[36:51]
    ds_read_b128 v[84:87], v249 offset:37888
    v_exp_f32 v95, v95
    v_exp_f32 v96, v96
    v_cvt_pk_bf16_f32 v234, v92, v93
    v_exp_f32 v97, v97
    v_cvt_pk_bf16_f32 v235, v94, v95
    v_mfma_f32_32x32x16_bf16 v[36:51], v[228:231], v[244:247], v[36:51]
    ds_read_b128 v[224:227], v249 offset:34816
    v_exp_f32 v98, v98
    v_exp_f32 v99, v99
    v_cvt_pk_bf16_f32 v236, v96, v97
    v_exp_f32 v100, v100
    v_smfmac_f32_16x16x64_bf16 v[56:59], v[60:63], v[240:247], v248
    ds_read_b128 v[228:231], v249 offset:35840
    v_exp_f32 v101, v101
    v_cvt_pk_bf16_f32 v237, v98, v99
    v_exp_f32 v102, v102
    v_exp_f32 v103, v103
    v_cvt_pk_bf16_f32 v238, v100, v101
    v_cvt_pk_bf16_f32 v239, v102, v103
    s_waitcnt lgkmcnt(2)
    v_mfma_f32_32x32x16_bf16 v[88:103], v[80:83], v[64:67], v[120:135]
    s_setprio 0
    v_exp_f32 v104, v104
    v_exp_f32 v105, v105
    v_exp_f32 v106, v106
    v_exp_f32 v107, v107
    v_mfma_f32_32x32x16_bf16 v[88:103], v[84:87], v[68:71], v[88:103]
    s_waitcnt lgkmcnt(0)
    v_cvt_pk_bf16_f32 v240, v104, v105
    v_exp_f32 v108, v108
    v_exp_f32 v109, v109
    v_cvt_pk_bf16_f32 v241, v106, v107
    v_exp_f32 v110, v110
    v_mfma_f32_32x32x16_bf16 v[20:35], v[224:227], v[232:235], v[20:35]
    v_exp_f32 v111, v111
    v_exp_f32 v112, v112
    v_cvt_pk_bf16_f32 v242, v108, v109
    v_exp_f32 v113, v113
    v_cvt_pk_bf16_f32 v243, v110, v111
    v_mfma_f32_32x32x16_bf16 v[20:35], v[228:231], v[236:239], v[20:35]
    s_waitcnt vmcnt(1)
    v_exp_f32 v114, v114
    v_exp_f32 v115, v115
    v_cvt_pk_bf16_f32 v244, v112, v113
    v_exp_f32 v116, v116
    v_smfmac_f32_16x16x64_bf16 v[52:55], v[60:63], v[232:239], v248
    s_barrier
    s_setprio 1
    v_exp_f32 v117, v117
    v_cvt_pk_bf16_f32 v245, v114, v115
    v_exp_f32 v118, v118
    v_exp_f32 v119, v119
    v_cvt_pk_bf16_f32 v246, v116, v117
    v_cvt_pk_bf16_f32 v247, v118, v119
    v_mfma_f32_32x32x16_bf16 v[104:119], v[80:83], v[72:75], v[120:135]
    s_mov_b32 m0, s85
    v_exp_f32 v88, v88
    v_exp_f32 v89, v89
    v_exp_f32 v90, v90
    v_exp_f32 v91, v91
    v_mfma_f32_32x32x16_bf16 v[104:119], v[84:87], v[76:79], v[104:119]
    ds_read_b128 v[80:83], v254 offset:0
    v_cvt_pk_bf16_f32 v232, v88, v89
    v_exp_f32 v92, v92
    v_exp_f32 v93, v93
    v_cvt_pk_bf16_f32 v233, v90, v91
    v_exp_f32 v94, v94
    v_mfma_f32_32x32x16_bf16 v[36:51], v[224:227], v[240:243], v[36:51]
    ds_read_b128 v[84:87], v254 offset:1024
    v_exp_f32 v95, v95
    v_exp_f32 v96, v96
    v_cvt_pk_bf16_f32 v234, v92, v93
    v_exp_f32 v97, v97
    v_cvt_pk_bf16_f32 v235, v94, v95
    v_mfma_f32_32x32x16_bf16 v[36:51], v[228:231], v[244:247], v[36:51]
    ds_read_b128 v[224:227], v249 offset:38912
    v_exp_f32 v98, v98
    v_exp_f32 v99, v99
    v_cvt_pk_bf16_f32 v236, v96, v97
    v_exp_f32 v100, v100
    v_smfmac_f32_16x16x64_bf16 v[56:59], v[60:63], v[240:247], v248
    ds_read_b128 v[228:231], v249 offset:39936
    v_exp_f32 v101, v101
    v_cvt_pk_bf16_f32 v237, v98, v99
    v_exp_f32 v102, v102
    v_exp_f32 v103, v103
    v_cvt_pk_bf16_f32 v238, v100, v101
    v_cvt_pk_bf16_f32 v239, v102, v103
    s_waitcnt lgkmcnt(2)
    v_mfma_f32_32x32x16_bf16 v[88:103], v[80:83], v[64:67], v[120:135]
    v_exp_f32 v104, v104
    v_exp_f32 v105, v105
    v_exp_f32 v106, v106
    v_exp_f32 v107, v107
    v_mfma_f32_32x32x16_bf16 v[88:103], v[84:87], v[68:71], v[88:103]
    s_waitcnt lgkmcnt(0)
    v_cvt_pk_bf16_f32 v240, v104, v105
    v_exp_f32 v108, v108
    v_exp_f32 v109, v109
    v_cvt_pk_bf16_f32 v241, v106, v107
    v_exp_f32 v110, v110
    v_mfma_f32_32x32x16_bf16 v[20:35], v[224:227], v[232:235], v[20:35]
    buffer_load_dwordx4 v1, s[80:83], s20 offen offset:0 sc1 lds
    v_exp_f32 v111, v111
    v_exp_f32 v112, v112
    v_cvt_pk_bf16_f32 v242, v108, v109
    v_exp_f32 v113, v113
    v_cvt_pk_bf16_f32 v243, v110, v111
    v_mfma_f32_32x32x16_bf16 v[20:35], v[228:231], v[236:239], v[20:35]
    v_exp_f32 v114, v114
    v_exp_f32 v115, v115
    v_cvt_pk_bf16_f32 v244, v112, v113
    v_exp_f32 v116, v116
    v_smfmac_f32_16x16x64_bf16 v[52:55], v[60:63], v[232:239], v248
    s_add_u32 s20, s20, 8192
    v_exp_f32 v117, v117
    v_cvt_pk_bf16_f32 v245, v114, v115
    v_exp_f32 v118, v118
    v_exp_f32 v119, v119
    v_cvt_pk_bf16_f32 v246, v116, v117
    v_cvt_pk_bf16_f32 v247, v118, v119
    v_mfma_f32_32x32x16_bf16 v[104:119], v[80:83], v[72:75], v[120:135]
    v_exp_f32 v88, v88
    v_exp_f32 v89, v89
    v_exp_f32 v90, v90
    v_exp_f32 v91, v91
    v_mfma_f32_32x32x16_bf16 v[104:119], v[84:87], v[76:79], v[104:119]
    ds_read_b128 v[80:83], v254 offset:4096
    v_cvt_pk_bf16_f32 v232, v88, v89
    v_exp_f32 v92, v92
    v_exp_f32 v93, v93
    v_cvt_pk_bf16_f32 v233, v90, v91
    v_exp_f32 v94, v94
    v_mfma_f32_32x32x16_bf16 v[36:51], v[224:227], v[240:243], v[36:51]
    ds_read_b128 v[84:87], v254 offset:5120
    v_exp_f32 v95, v95
    v_exp_f32 v96, v96
    v_cvt_pk_bf16_f32 v234, v92, v93
    v_exp_f32 v97, v97
    v_cvt_pk_bf16_f32 v235, v94, v95
    v_mfma_f32_32x32x16_bf16 v[36:51], v[228:231], v[244:247], v[36:51]
    ds_read_b128 v[224:227], v254 offset:2048
    v_exp_f32 v98, v98
    v_exp_f32 v99, v99
    v_cvt_pk_bf16_f32 v236, v96, v97
    v_exp_f32 v100, v100
    v_smfmac_f32_16x16x64_bf16 v[56:59], v[60:63], v[240:247], v248
    ds_read_b128 v[228:231], v254 offset:3072
    v_exp_f32 v101, v101
    v_cvt_pk_bf16_f32 v237, v98, v99
    v_exp_f32 v102, v102
    v_exp_f32 v103, v103
    v_cvt_pk_bf16_f32 v238, v100, v101
    v_cvt_pk_bf16_f32 v239, v102, v103
    s_waitcnt lgkmcnt(2)
    v_mfma_f32_32x32x16_bf16 v[88:103], v[80:83], v[64:67], v[120:135]
    s_setprio 0
    v_exp_f32 v104, v104
    v_exp_f32 v105, v105
    v_exp_f32 v106, v106
    v_exp_f32 v107, v107
    v_mfma_f32_32x32x16_bf16 v[88:103], v[84:87], v[68:71], v[88:103]
    s_waitcnt lgkmcnt(0)
    v_cvt_pk_bf16_f32 v240, v104, v105
    v_exp_f32 v108, v108
    v_exp_f32 v109, v109
    v_cvt_pk_bf16_f32 v241, v106, v107
    v_exp_f32 v110, v110
    v_mfma_f32_32x32x16_bf16 v[20:35], v[224:227], v[232:235], v[20:35]
    v_exp_f32 v111, v111
    v_exp_f32 v112, v112
    v_cvt_pk_bf16_f32 v242, v108, v109
    v_exp_f32 v113, v113
    v_cvt_pk_bf16_f32 v243, v110, v111
    v_mfma_f32_32x32x16_bf16 v[20:35], v[228:231], v[236:239], v[20:35]
    s_waitcnt vmcnt(1)
    v_exp_f32 v114, v114
    v_exp_f32 v115, v115
    v_cvt_pk_bf16_f32 v244, v112, v113
    v_exp_f32 v116, v116
    v_smfmac_f32_16x16x64_bf16 v[52:55], v[60:63], v[232:239], v248
    s_barrier
    s_setprio 1
    v_exp_f32 v117, v117
    v_cvt_pk_bf16_f32 v245, v114, v115
    v_exp_f32 v118, v118
    v_exp_f32 v119, v119
    v_cvt_pk_bf16_f32 v246, v116, v117
    v_cvt_pk_bf16_f32 v247, v118, v119
    v_mfma_f32_32x32x16_bf16 v[104:119], v[80:83], v[72:75], v[120:135]
    s_mov_b32 m0, s86
    v_exp_f32 v88, v88
    v_exp_f32 v89, v89
    v_exp_f32 v90, v90
    v_exp_f32 v91, v91
    v_mfma_f32_32x32x16_bf16 v[104:119], v[84:87], v[76:79], v[104:119]
    ds_read_b128 v[80:83], v254 offset:32768
    v_cvt_pk_bf16_f32 v232, v88, v89
    v_exp_f32 v92, v92
    v_exp_f32 v93, v93
    v_cvt_pk_bf16_f32 v233, v90, v91
    v_exp_f32 v94, v94
    v_mfma_f32_32x32x16_bf16 v[36:51], v[224:227], v[240:243], v[36:51]
    ds_read_b128 v[84:87], v254 offset:33792
    v_exp_f32 v95, v95
    v_exp_f32 v96, v96
    v_cvt_pk_bf16_f32 v234, v92, v93
    v_exp_f32 v97, v97
    v_cvt_pk_bf16_f32 v235, v94, v95
    v_mfma_f32_32x32x16_bf16 v[36:51], v[228:231], v[244:247], v[36:51]
    ds_read_b128 v[224:227], v254 offset:6144
    v_exp_f32 v98, v98
    v_exp_f32 v99, v99
    v_cvt_pk_bf16_f32 v236, v96, v97
    v_exp_f32 v100, v100
    v_smfmac_f32_16x16x64_bf16 v[56:59], v[60:63], v[240:247], v248
    ds_read_b128 v[228:231], v254 offset:7168
    v_exp_f32 v101, v101
    v_cvt_pk_bf16_f32 v237, v98, v99
    v_exp_f32 v102, v102
    v_exp_f32 v103, v103
    v_cvt_pk_bf16_f32 v238, v100, v101
    v_cvt_pk_bf16_f32 v239, v102, v103
    s_waitcnt lgkmcnt(2)
    v_mfma_f32_32x32x16_bf16 v[88:103], v[80:83], v[64:67], v[120:135]
    v_exp_f32 v104, v104
    v_exp_f32 v105, v105
    v_exp_f32 v106, v106
    v_exp_f32 v107, v107
    v_mfma_f32_32x32x16_bf16 v[88:103], v[84:87], v[68:71], v[88:103]
    s_waitcnt lgkmcnt(0)
    v_cvt_pk_bf16_f32 v240, v104, v105
    v_exp_f32 v108, v108
    v_exp_f32 v109, v109
    v_cvt_pk_bf16_f32 v241, v106, v107
    v_exp_f32 v110, v110
    v_mfma_f32_32x32x16_bf16 v[20:35], v[224:227], v[232:235], v[20:35]
    buffer_load_dwordx4 v1, s[80:83], s20 offen offset:0 sc1 lds
    v_exp_f32 v111, v111
    v_exp_f32 v112, v112
    v_cvt_pk_bf16_f32 v242, v108, v109
    v_exp_f32 v113, v113
    v_cvt_pk_bf16_f32 v243, v110, v111
    v_mfma_f32_32x32x16_bf16 v[20:35], v[228:231], v[236:239], v[20:35]
    v_exp_f32 v114, v114
    v_exp_f32 v115, v115
    v_cvt_pk_bf16_f32 v244, v112, v113
    v_exp_f32 v116, v116
    v_smfmac_f32_16x16x64_bf16 v[52:55], v[60:63], v[232:239], v248
    s_add_u32 s20, s20, 8192
    v_exp_f32 v117, v117
    v_cvt_pk_bf16_f32 v245, v114, v115
    v_exp_f32 v118, v118
    v_exp_f32 v119, v119
    v_cvt_pk_bf16_f32 v246, v116, v117
    v_cvt_pk_bf16_f32 v247, v118, v119
    v_mfma_f32_32x32x16_bf16 v[104:119], v[80:83], v[72:75], v[120:135]
    v_exp_f32 v88, v88
    v_exp_f32 v89, v89
    v_exp_f32 v90, v90
    v_exp_f32 v91, v91
    v_mfma_f32_32x32x16_bf16 v[104:119], v[84:87], v[76:79], v[104:119]
    ds_read_b128 v[80:83], v254 offset:36864
    v_cvt_pk_bf16_f32 v232, v88, v89
    v_exp_f32 v92, v92
    v_exp_f32 v93, v93
    v_cvt_pk_bf16_f32 v233, v90, v91
    v_exp_f32 v94, v94
    v_mfma_f32_32x32x16_bf16 v[36:51], v[224:227], v[240:243], v[36:51]
    ds_read_b128 v[84:87], v254 offset:37888
    v_exp_f32 v95, v95
    v_exp_f32 v96, v96
    v_cvt_pk_bf16_f32 v234, v92, v93
    v_exp_f32 v97, v97
    v_cvt_pk_bf16_f32 v235, v94, v95
    v_mfma_f32_32x32x16_bf16 v[36:51], v[228:231], v[244:247], v[36:51]
    ds_read_b128 v[224:227], v254 offset:34816
    v_exp_f32 v98, v98
    v_exp_f32 v99, v99
    v_cvt_pk_bf16_f32 v236, v96, v97
    v_exp_f32 v100, v100
    v_smfmac_f32_16x16x64_bf16 v[56:59], v[60:63], v[240:247], v248
    ds_read_b128 v[228:231], v254 offset:35840
    v_exp_f32 v101, v101
    v_cvt_pk_bf16_f32 v237, v98, v99
    v_exp_f32 v102, v102
    v_exp_f32 v103, v103
    v_cvt_pk_bf16_f32 v238, v100, v101
    v_cvt_pk_bf16_f32 v239, v102, v103
    s_waitcnt lgkmcnt(2)
    v_mfma_f32_32x32x16_bf16 v[88:103], v[80:83], v[64:67], v[120:135]
    s_setprio 0
    v_exp_f32 v104, v104
    v_exp_f32 v105, v105
    v_exp_f32 v106, v106
    v_exp_f32 v107, v107
    v_mfma_f32_32x32x16_bf16 v[88:103], v[84:87], v[68:71], v[88:103]
    s_waitcnt lgkmcnt(0)
    v_cvt_pk_bf16_f32 v240, v104, v105
    v_exp_f32 v108, v108
    v_exp_f32 v109, v109
    v_cvt_pk_bf16_f32 v241, v106, v107
    v_exp_f32 v110, v110
    v_mfma_f32_32x32x16_bf16 v[20:35], v[224:227], v[232:235], v[20:35]
    s_sub_u32 s10, s10, 1
    v_exp_f32 v111, v111
    v_exp_f32 v112, v112
    v_cvt_pk_bf16_f32 v242, v108, v109
    v_exp_f32 v113, v113
    v_cvt_pk_bf16_f32 v243, v110, v111
    v_mfma_f32_32x32x16_bf16 v[20:35], v[228:231], v[236:239], v[20:35]
    s_waitcnt vmcnt(1)
    v_exp_f32 v114, v114
    v_exp_f32 v115, v115
    v_cvt_pk_bf16_f32 v244, v112, v113
    v_exp_f32 v116, v116
    v_smfmac_f32_16x16x64_bf16 v[52:55], v[60:63], v[232:239], v248
    s_barrier
    s_setprio 1
    v_exp_f32 v117, v117
    v_cvt_pk_bf16_f32 v245, v114, v115
    v_exp_f32 v118, v118
    v_exp_f32 v119, v119
    v_cvt_pk_bf16_f32 v246, v116, v117
    v_cvt_pk_bf16_f32 v247, v118, v119
    v_mfma_f32_32x32x16_bf16 v[104:119], v[80:83], v[72:75], v[120:135]
    s_mov_b32 m0, s87
    v_exp_f32 v88, v88
    v_exp_f32 v89, v89
    v_exp_f32 v90, v90
    v_exp_f32 v91, v91
    v_mfma_f32_32x32x16_bf16 v[104:119], v[84:87], v[76:79], v[104:119]
    ds_read_b128 v[80:83], v249 offset:0
    v_cvt_pk_bf16_f32 v232, v88, v89
    v_exp_f32 v92, v92
    v_exp_f32 v93, v93
    v_cvt_pk_bf16_f32 v233, v90, v91
    v_exp_f32 v94, v94
    v_mfma_f32_32x32x16_bf16 v[36:51], v[224:227], v[240:243], v[36:51]
    ds_read_b128 v[84:87], v249 offset:1024
    v_exp_f32 v95, v95
    v_exp_f32 v96, v96
    v_cvt_pk_bf16_f32 v234, v92, v93
    v_exp_f32 v97, v97
    v_cvt_pk_bf16_f32 v235, v94, v95
    v_mfma_f32_32x32x16_bf16 v[36:51], v[228:231], v[244:247], v[36:51]
    ds_read_b128 v[224:227], v254 offset:38912
    v_exp_f32 v98, v98
    v_exp_f32 v99, v99
    v_cvt_pk_bf16_f32 v236, v96, v97
    v_exp_f32 v100, v100
    v_smfmac_f32_16x16x64_bf16 v[56:59], v[60:63], v[240:247], v248
    ds_read_b128 v[228:231], v254 offset:39936
    v_exp_f32 v101, v101
    v_cvt_pk_bf16_f32 v237, v98, v99
    v_exp_f32 v102, v102
    v_exp_f32 v103, v103
    v_cvt_pk_bf16_f32 v238, v100, v101
    v_cvt_pk_bf16_f32 v239, v102, v103
    s_waitcnt lgkmcnt(2)
    v_mfma_f32_32x32x16_bf16 v[88:103], v[80:83], v[64:67], v[120:135]
    v_exp_f32 v104, v104
    v_exp_f32 v105, v105
    v_exp_f32 v106, v106
    v_exp_f32 v107, v107
    v_mfma_f32_32x32x16_bf16 v[88:103], v[84:87], v[68:71], v[88:103]
    s_waitcnt lgkmcnt(0)
    v_cvt_pk_bf16_f32 v240, v104, v105
    v_exp_f32 v108, v108
    v_exp_f32 v109, v109
    v_cvt_pk_bf16_f32 v241, v106, v107
    v_exp_f32 v110, v110
    v_mfma_f32_32x32x16_bf16 v[20:35], v[224:227], v[232:235], v[20:35]
    buffer_load_dwordx4 v1, s[80:83], s20 offen offset:0 sc1 lds
    v_exp_f32 v111, v111
    v_exp_f32 v112, v112
    v_cvt_pk_bf16_f32 v242, v108, v109
    v_exp_f32 v113, v113
    v_cvt_pk_bf16_f32 v243, v110, v111
    v_mfma_f32_32x32x16_bf16 v[20:35], v[228:231], v[236:239], v[20:35]
    v_exp_f32 v114, v114
    v_exp_f32 v115, v115
    v_cvt_pk_bf16_f32 v244, v112, v113
    v_exp_f32 v116, v116
    v_smfmac_f32_16x16x64_bf16 v[52:55], v[60:63], v[232:239], v248
    s_add_u32 s20, s20, 8192
    v_exp_f32 v117, v117
    v_cvt_pk_bf16_f32 v245, v114, v115
    v_exp_f32 v118, v118
    v_exp_f32 v119, v119
    v_cvt_pk_bf16_f32 v246, v116, v117
    v_cvt_pk_bf16_f32 v247, v118, v119
    s_cmp_lg_u32 s10, 0
    s_cbranch_scc0 KF_AD
    s_lshr_b32 s11, 130, s10
    s_bitcmp1_b32 s11, 0
    s_cbranch_scc0 KF_AL1
    s_cmp_eq_u32 s10, 1
    s_cbranch_scc1 KF_HL1
    s_cmp_lg_u32 s8, 0
    s_cbranch_scc1 KF_AL1
    s_lshl_b32 s11, s7, 2
    s_add_u32 s11, s11, 192
    v_mov_b32 v5, 1
    v_mov_b32 v6, s11
    s_mov_b64 exec, 1
    buffer_atomic_add v5, v6, s[60:63], 0 offen sc1
    s_mov_b64 exec, -1
    s_branch KF_AL1
KF_HL1:
    s_mov_b32 s85, 131072
    s_mov_b32 s86, 131072
    s_mov_b32 s87, 131072
    s_and_b32 s11, s6, 7
    s_lshl_b32 s11, s11, 3
    s_add_u32 s11, s11, s8
    s_lshl_b32 s11, s11, 15
    s_lshl_b32 s12, s3, 8
    s_add_u32 s11, s11, s12
    v_lshrrev_b32 v5, 4, v0
    v_and_b32 v6, 15, v0
    v_lshlrev_b32 v6, 4, v6
    v_lshl_add_u32 v5, v5, 11, v6
    buffer_load_dwordx4 v[250:253], v5, s[24:27], s11 offen
    s_add_u32 s11, s11, 8192
    buffer_load_dwordx4 v[250:253], v5, s[24:27], s11 offen
    s_add_u32 s11, s11, 8192
    buffer_load_dwordx4 v[250:253], v5, s[24:27], s11 offen
    s_add_u32 s11, s11, 8192
    buffer_load_dwordx4 v[250:253], v5, s[24:27], s11 offen
    s_add_u32 s11, s11, 8192
    s_lshl_b32 s11, s8, 10
    s_add_u32 s11, s11, KF_AD - KF_PC
    buffer_load_dwordx4 v[250:253], v1, s[76:79], s11 offen
    s_add_u32 s11, s11, 8192
    buffer_load_dwordx4 v[250:253], v1, s[76:79], s11 offen
    s_add_u32 s11, s11, 8192
    s_and_b32 s13, s8, 3
    v_lshrrev_b32 v5, 4, v0
    v_lshrrev_b32 v6, 1, v0
    v_and_b32 v6, 7, v6
    v_xor_b32 v6, v6, v5
    v_lshlrev_b32 v6, 5, v6
    v_and_b32 v7, 1, v0
    v_lshl_add_u32 v6, v7, 4, v6
    v_lshl_add_u32 v10, v5, 11, v6
    v_xor_b32 v11, 128, v10
    s_lshl_b32 s70, s13, 15
    s_lshl_b32 s11, s3, 8
    s_add_u32 s70, s70, s11
    s_lshl_b32 s71, s13, 12
    s_mov_b32 s75, 2
    s_lshr_b32 s11, s88, 1
    s_lshl_b32 s11, s11, 15
    s_lshl_b32 s12, s89, 13
    s_add_u32 s11, s11, s12
    s_and_b32 s12, s88, 1
    s_lshl_b32 s12, s12, 11
    s_add_u32 s11, s11, s12
    v_add_u32 v13, s11, v1
    v_lshrrev_b32 v14, 3, v0
    v_and_b32 v12, 7, v0
    v_lshlrev_b32 v12, 2, v12
    v_lshl_add_u32 v14, v14, 7, v12
    s_lshl_b32 s11, s3, 5
    s_add_u32 s11, s11, s8
    s_lshl_b32 s11, s11, 2
    v_mov_b32 v12, s11
    s_add_u32 s69, s94, 12582912
    s_branch KF_AL1
KF_AD:
    v_mfma_f32_32x32x16_bf16 v[36:51], v[224:227], v[240:243], v[36:51]
    v_mfma_f32_32x32x16_bf16 v[36:51], v[228:231], v[244:247], v[36:51]
    v_smfmac_f32_16x16x64_bf16 v[56:59], v[60:63], v[240:247], v248
    s_mov_b32 s90, 0
    s_cmp_lg_u32 s8, 4
    s_cbranch_scc1 KF_NWO
    buffer_load_dword v15, v14, s[52:55], s95 offen sc0 sc1
KF_NWO:
KF_FIN:
    s_nop 15
    s_mov_b64 s[18:19], 0
    v_add_f32 v52, v52, v53
    v_add_f32 v56, v56, v57
    v_rcp_f32 v4, v52
    v_cmp_ngt_f32 vcc, s91, v52
    v_mov_b32 v5, v4
    s_or_b64 s[18:19], s[18:19], vcc
    v_rcp_f32 v6, v56
    v_cmp_ngt_f32 vcc, s91, v56
    v_mov_b32 v7, v6
    s_or_b64 s[18:19], s[18:19], vcc
    v_pk_mul_f32 v[88:89], v[20:21], v[4:5]
    v_pk_mul_f32 v[90:91], v[22:23], v[4:5]
    v_pk_mul_f32 v[92:93], v[24:25], v[4:5]
    v_pk_mul_f32 v[94:95], v[26:27], v[4:5]
    v_pk_mul_f32 v[96:97], v[28:29], v[4:5]
    v_pk_mul_f32 v[98:99], v[30:31], v[4:5]
    v_pk_mul_f32 v[100:101], v[32:33], v[4:5]
    v_pk_mul_f32 v[102:103], v[34:35], v[4:5]
    v_cvt_pk_bf16_f32 v232, v88, v89
    v_cvt_pk_bf16_f32 v233, v90, v91
    v_cvt_pk_bf16_f32 v234, v92, v93
    v_cvt_pk_bf16_f32 v235, v94, v95
    v_cvt_pk_bf16_f32 v236, v96, v97
    v_cvt_pk_bf16_f32 v237, v98, v99
    v_cvt_pk_bf16_f32 v238, v100, v101
    v_cvt_pk_bf16_f32 v239, v102, v103
    s_add_u32 s17, s23, 0
    buffer_store_dwordx4 v[232:235], v1, s[52:55], s17 offen sc0 sc1
    buffer_store_dwordx4 v[236:239], v1, s[52:55], s17 offen offset:1024 sc0 sc1
    ds_write_b128 v13, v[232:235] offset:0
    ds_write_b128 v13, v[236:239] offset:1024
    v_pk_mul_f32 v[104:105], v[36:37], v[6:7]
    v_pk_mul_f32 v[106:107], v[38:39], v[6:7]
    v_pk_mul_f32 v[108:109], v[40:41], v[6:7]
    v_pk_mul_f32 v[110:111], v[42:43], v[6:7]
    v_pk_mul_f32 v[112:113], v[44:45], v[6:7]
    v_pk_mul_f32 v[114:115], v[46:47], v[6:7]
    v_pk_mul_f32 v[116:117], v[48:49], v[6:7]
    v_pk_mul_f32 v[118:119], v[50:51], v[6:7]
    v_cvt_pk_bf16_f32 v240, v104, v105
    v_cvt_pk_bf16_f32 v241, v106, v107
    v_cvt_pk_bf16_f32 v242, v108, v109
    v_cvt_pk_bf16_f32 v243, v110, v111
    v_cvt_pk_bf16_f32 v244, v112, v113
    v_cvt_pk_bf16_f32 v245, v114, v115
    v_cvt_pk_bf16_f32 v246, v116, v117
    v_cvt_pk_bf16_f32 v247, v118, v119
    s_add_u32 s17, s23, 65536
    buffer_store_dwordx4 v[240:243], v1, s[52:55], s17 offen sc0 sc1
    buffer_store_dwordx4 v[244:247], v1, s[52:55], s17 offen offset:1024 sc0 sc1
    ds_write_b128 v13, v[240:243] offset:4096
    ds_write_b128 v13, v[244:247] offset:5120
    v_pk_mul_f32 v[4:5], v[88:89], 0
    v_pk_fma_f32 v[4:5], v[90:91], 0, v[4:5]
    v_pk_fma_f32 v[4:5], v[92:93], 0, v[4:5]
    v_pk_fma_f32 v[4:5], v[94:95], 0, v[4:5]
    v_pk_fma_f32 v[4:5], v[96:97], 0, v[4:5]
    v_pk_fma_f32 v[4:5], v[98:99], 0, v[4:5]
    v_pk_fma_f32 v[4:5], v[100:101], 0, v[4:5]
    v_pk_fma_f32 v[4:5], v[102:103], 0, v[4:5]
    v_pk_fma_f32 v[4:5], v[104:105], 0, v[4:5]
    v_pk_fma_f32 v[4:5], v[106:107], 0, v[4:5]
    v_pk_fma_f32 v[4:5], v[108:109], 0, v[4:5]
    v_pk_fma_f32 v[4:5], v[110:111], 0, v[4:5]
    v_pk_fma_f32 v[4:5], v[112:113], 0, v[4:5]
    v_pk_fma_f32 v[4:5], v[114:115], 0, v[4:5]
    v_pk_fma_f32 v[4:5], v[116:117], 0, v[4:5]
    v_pk_fma_f32 v[4:5], v[118:119], 0, v[4:5]
    v_cmp_u_f32 vcc, v4, v5
    s_cmp_lg_u32 s90, 0
    s_cbranch_scc1 KF_DONE
    s_or_b64 s[18:19], s[18:19], vcc
    s_cbranch_scc0 KF_DONE
    v_mov_b32 v8, 0xff800000
    v_mov_b32 v9, 0xff800000
    s_mov_b32 s20, 0
KF_SL1:
    buffer_load_dwordx4 v[80:83], v1, s[80:83], s20 offen sc1
    buffer_load_dwordx4 v[84:87], v1, s[80:83], s20 offen offset:1024 sc1
    s_waitcnt vmcnt(0)
    v_mfma_f32_32x32x16_bf16 v[88:103], v[80:83], v[64:67], 0
    v_mfma_f32_32x32x16_bf16 v[88:103], v[84:87], v[68:71], v[88:103]
    s_nop 15
    v_max3_f32 v8, v8, v88, v89
    v_max3_f32 v8, v8, v90, v91
    v_max3_f32 v8, v8, v92, v93
    v_max3_f32 v8, v8, v94, v95
    v_max3_f32 v8, v8, v96, v97
    v_max3_f32 v8, v8, v98, v99
    v_max3_f32 v8, v8, v100, v101
    v_max3_f32 v8, v8, v102, v103
    v_mfma_f32_32x32x16_bf16 v[88:103], v[80:83], v[72:75], 0
    v_mfma_f32_32x32x16_bf16 v[88:103], v[84:87], v[76:79], v[88:103]
    s_nop 15
    v_max3_f32 v9, v9, v88, v89
    v_max3_f32 v9, v9, v90, v91
    v_max3_f32 v9, v9, v92, v93
    v_max3_f32 v9, v9, v94, v95
    v_max3_f32 v9, v9, v96, v97
    v_max3_f32 v9, v9, v98, v99
    v_max3_f32 v9, v9, v100, v101
    v_max3_f32 v9, v9, v102, v103
    s_add_u32 s20, s20, 4096
    s_cmp_lt_u32 s20, 0x40000
    s_cbranch_scc1 KF_SL1
    v_mov_b32 v4, v8
    s_nop 1
    v_permlane32_swap_b32 v8, v4
    s_nop 1
    v_max_f32 v8, v8, v4
    v_mov_b32 v4, v9
    s_nop 1
    v_permlane32_swap_b32 v9, v4
    s_nop 1
    v_max_f32 v9, v9, v4
    v_mov_b32 v20, 0
    v_mov_b32 v21, 0
    v_mov_b32 v22, 0
    v_mov_b32 v23, 0
    v_mov_b32 v24, 0
    v_mov_b32 v25, 0
    v_mov_b32 v26, 0
    v_mov_b32 v27, 0
    v_mov_b32 v28, 0
    v_mov_b32 v29, 0
    v_mov_b32 v30, 0
    v_mov_b32 v31, 0
    v_mov_b32 v32, 0
    v_mov_b32 v33, 0
    v_mov_b32 v34, 0
    v_mov_b32 v35, 0
    v_mov_b32 v36, 0
    v_mov_b32 v37, 0
    v_mov_b32 v38, 0
    v_mov_b32 v39, 0
    v_mov_b32 v40, 0
    v_mov_b32 v41, 0
    v_mov_b32 v42, 0
    v_mov_b32 v43, 0
    v_mov_b32 v44, 0
    v_mov_b32 v45, 0
    v_mov_b32 v46, 0
    v_mov_b32 v47, 0
    v_mov_b32 v48, 0
    v_mov_b32 v49, 0
    v_mov_b32 v50, 0
    v_mov_b32 v51, 0
    v_mov_b32 v52, 0
    v_mov_b32 v53, 0
    v_mov_b32 v54, 0
    v_mov_b32 v55, 0
    v_mov_b32 v56, 0
    v_mov_b32 v57, 0
    v_mov_b32 v58, 0
    v_mov_b32 v59, 0
    s_mov_b32 s20, 0
KF_SL2:
    buffer_load_dwordx4 v[80:83], v1, s[80:83], s20 offen sc1
    buffer_load_dwordx4 v[84:87], v1, s[80:83], s20 offen offset:1024 sc1
    buffer_load_dwordx4 v[224:227], v1, s[80:83], s20 offen offset:2048 sc1
    buffer_load_dwordx4 v[228:231], v1, s[80:83], s20 offen offset:3072 sc1
    v_sub_f32 v120, 0, v8
    v_sub_f32 v121, 0, v8
    v_sub_f32 v122, 0, v8
    v_sub_f32 v123, 0, v8
    v_sub_f32 v124, 0, v8
    v_sub_f32 v125, 0, v8
    v_sub_f32 v126, 0, v8
    v_sub_f32 v127, 0, v8
    v_sub_f32 v128, 0, v8
    v_sub_f32 v129, 0, v8
    v_sub_f32 v130, 0, v8
    v_sub_f32 v131, 0, v8
    v_sub_f32 v132, 0, v8
    v_sub_f32 v133, 0, v8
    v_sub_f32 v134, 0, v8
    v_sub_f32 v135, 0, v8
    s_waitcnt vmcnt(0)
    s_nop 0
    v_mfma_f32_32x32x16_bf16 v[88:103], v[80:83], v[64:67], v[120:135]
    v_mfma_f32_32x32x16_bf16 v[88:103], v[84:87], v[68:71], v[88:103]
    s_nop 15
    v_exp_f32 v88, v88
    v_exp_f32 v89, v89
    v_exp_f32 v90, v90
    v_exp_f32 v91, v91
    v_cvt_pk_bf16_f32 v232, v88, v89
    v_exp_f32 v92, v92
    v_exp_f32 v93, v93
    v_cvt_pk_bf16_f32 v233, v90, v91
    v_exp_f32 v94, v94
    v_exp_f32 v95, v95
    v_exp_f32 v96, v96
    v_cvt_pk_bf16_f32 v234, v92, v93
    v_exp_f32 v97, v97
    v_cvt_pk_bf16_f32 v235, v94, v95
    v_exp_f32 v98, v98
    v_exp_f32 v99, v99
    v_cvt_pk_bf16_f32 v236, v96, v97
    v_exp_f32 v100, v100
    v_exp_f32 v101, v101
    v_cvt_pk_bf16_f32 v237, v98, v99
    v_exp_f32 v102, v102
    v_exp_f32 v103, v103
    v_cvt_pk_bf16_f32 v238, v100, v101
    v_cvt_pk_bf16_f32 v239, v102, v103
    s_nop 1
    v_mfma_f32_32x32x16_bf16 v[20:35], v[224:227], v[232:235], v[20:35]
    v_mfma_f32_32x32x16_bf16 v[20:35], v[228:231], v[236:239], v[20:35]
    v_smfmac_f32_16x16x64_bf16 v[52:55], v[60:63], v[232:239], v248
    s_nop 7
    v_sub_f32 v120, 0, v9
    v_sub_f32 v121, 0, v9
    v_sub_f32 v122, 0, v9
    v_sub_f32 v123, 0, v9
    v_sub_f32 v124, 0, v9
    v_sub_f32 v125, 0, v9
    v_sub_f32 v126, 0, v9
    v_sub_f32 v127, 0, v9
    v_sub_f32 v128, 0, v9
    v_sub_f32 v129, 0, v9
    v_sub_f32 v130, 0, v9
    v_sub_f32 v131, 0, v9
    v_sub_f32 v132, 0, v9
    v_sub_f32 v133, 0, v9
    v_sub_f32 v134, 0, v9
    v_sub_f32 v135, 0, v9
    s_waitcnt vmcnt(0)
    s_nop 0
    v_mfma_f32_32x32x16_bf16 v[88:103], v[80:83], v[72:75], v[120:135]
    v_mfma_f32_32x32x16_bf16 v[88:103], v[84:87], v[76:79], v[88:103]
    s_nop 15
    v_exp_f32 v88, v88
    v_exp_f32 v89, v89
    v_exp_f32 v90, v90
    v_exp_f32 v91, v91
    v_cvt_pk_bf16_f32 v232, v88, v89
    v_exp_f32 v92, v92
    v_exp_f32 v93, v93
    v_cvt_pk_bf16_f32 v233, v90, v91
    v_exp_f32 v94, v94
    v_exp_f32 v95, v95
    v_exp_f32 v96, v96
    v_cvt_pk_bf16_f32 v234, v92, v93
    v_exp_f32 v97, v97
    v_cvt_pk_bf16_f32 v235, v94, v95
    v_exp_f32 v98, v98
    v_exp_f32 v99, v99
    v_cvt_pk_bf16_f32 v236, v96, v97
    v_exp_f32 v100, v100
    v_exp_f32 v101, v101
    v_cvt_pk_bf16_f32 v237, v98, v99
    v_exp_f32 v102, v102
    v_exp_f32 v103, v103
    v_cvt_pk_bf16_f32 v238, v100, v101
    v_cvt_pk_bf16_f32 v239, v102, v103
    s_nop 1
    v_mfma_f32_32x32x16_bf16 v[36:51], v[224:227], v[232:235], v[36:51]
    v_mfma_f32_32x32x16_bf16 v[36:51], v[228:231], v[236:239], v[36:51]
    v_smfmac_f32_16x16x64_bf16 v[56:59], v[60:63], v[232:239], v248
    s_nop 7
    s_add_u32 s20, s20, 4096
    s_cmp_lt_u32 s20, 0x40000
    s_cbranch_scc1 KF_SL2
    s_mov_b32 s90, 1
    s_branch KF_FIN
KF_DONE:
    s_setprio 0
    s_cmp_ge_u32 s8, 4
    s_cbranch_scc1 KF_PL
    s_lshl_b32 s11, s3, 1
    s_lshl_b32 s12, s11, 17
    s_add_u32 s12, s12, s70
    s_add_u32 m0, s71, 0
    s_add_u32 m0, m0, 16384
    s_nop 0
    buffer_load_dwordx4 v10, s[24:27], s12 offen lds
    s_add_u32 m0, m0, 1024
    s_add_u32 s12, s12, 8192
    buffer_load_dwordx4 v11, s[24:27], s12 offen lds
    s_add_u32 m0, m0, 1024
    s_add_u32 s12, s12, 8192
    buffer_load_dwordx4 v10, s[24:27], s12 offen lds
    s_add_u32 m0, m0, 1024
    s_add_u32 s12, s12, 8192
    buffer_load_dwordx4 v11, s[24:27], s12 offen lds
    s_lshl_b32 s11, s3, 1
    s_add_u32 s11, s11, 1
    s_lshl_b32 s12, s11, 17
    s_add_u32 s12, s12, s70
    s_add_u32 m0, s71, 32768
    s_add_u32 m0, m0, 16384
    s_nop 0
    buffer_load_dwordx4 v10, s[24:27], s12 offen lds
    s_add_u32 m0, m0, 1024
    s_add_u32 s12, s12, 8192
    buffer_load_dwordx4 v11, s[24:27], s12 offen lds
    s_add_u32 m0, m0, 1024
    s_add_u32 s12, s12, 8192
    buffer_load_dwordx4 v10, s[24:27], s12 offen lds
    s_add_u32 m0, m0, 1024
    s_add_u32 s12, s12, 8192
    buffer_load_dwordx4 v11, s[24:27], s12 offen lds
    v_mov_b32 v18, v12
    v_and_b32 v2, 15, v0
    v_lshrrev_b32 v3, 4, v0
    s_and_b32 s9, s8, 1
    s_lshl_b32 s9, s9, 13
    v_lshlrev_b32 v4, 9, v3
    v_lshl_add_u32 v4, v2, 4, v4
    v_add_u32 v8, s9, v4
    v_lshrrev_b32 v2, 2, v2
    v_and_b32 v4, 1, v3
    v_lshl_add_u32 v4, v4, 2, v2
    v_lshrrev_b32 v5, 1, v3
    v_lshl_add_u32 v5, v5, 4, v4
    s_and_b32 s9, s8, 2
    s_lshl_b32 s9, s9, 1
    v_xor_b32 v4, s9, v4
    v_lshlrev_b32 v4, 5, v4
    v_lshl_add_u32 v4, v5, 8, v4
    v_and_b32 v5, 3, v0
    v_lshl_add_u32 v4, v5, 3, v4
    v_add_u32 v9, 16384, v4
    v_xor_b32 v10, 32, v9
    v_xor_b32 v11, 64, v9
    v_xor_b32 v12, 96, v9
    v_add_u32 v13, 65536, v8
    v_add_u32 v14, 65536, v9
    v_add_u32 v15, 65536, v10
    v_add_u32 v16, 65536, v11
    v_add_u32 v17, 65536, v12
    v_mov_b32 v19, 1
    s_mov_b32 s10, 4
    s_waitcnt vmcnt(8) lgkmcnt(0)
    s_mov_b64 exec, 1
    buffer_store_dword v19, v18, s[52:55], s95 offen sc0 sc1
    s_mov_b64 exec, -1
    s_lshl_b32 s11, s6, 7
    s_and_b32 s9, s8, 1
    s_lshl_b32 s9, s9, 6
    s_add_u32 s11, s11, s9
    s_lshl_b32 s11, s11, 12
    s_xor_b32 s12, s5, 1
    s_lshl_b32 s12, s12, 11
    s_add_u32 s11, s11, s12
    s_lshl_b32 s12, s3, 8
    s_add_u32 s11, s11, s12
    s_and_b32 s9, s8, 2
    s_lshl_b32 s9, s9, 6
    s_add_u32 s11, s11, s9
    s_mul_i32 s12, s8, 9216
    v_and_b32 v2, 15, v0
    v_mul_u32_u24 v2, 144, v2
    v_lshl_add_u32 v2, v3, 3, v2
    v_add_u32 v2, s12, v2
    v_lshrrev_b32 v4, 3, v0
    v_and_b32 v5, 7, v0
    v_mul_u32_u24 v6, 144, v4
    v_lshl_add_u32 v6, v5, 4, v6
    v_add_u32 v6, s12, v6
    v_lshlrev_b32 v7, 12, v4
    v_lshl_add_u32 v7, v5, 4, v7
    s_waitcnt vmcnt(1)
    s_barrier
    ds_read_b64_tr_b16 v[80:81], v9 offset:0
    ds_read_b64_tr_b16 v[82:83], v9 offset:2048
    ds_read_b128 v[64:67], v8 offset:0
    ds_read_b64_tr_b16 v[84:85], v10 offset:0
    ds_read_b64_tr_b16 v[86:87], v10 offset:2048
    ds_read_b128 v[68:71], v8 offset:256
    ds_read_b64_tr_b16 v[88:89], v11 offset:0
    ds_read_b64_tr_b16 v[90:91], v11 offset:2048
    ds_read_b128 v[72:75], v8 offset:4096
    ds_read_b64_tr_b16 v[92:93], v12 offset:0
    ds_read_b64_tr_b16 v[94:95], v12 offset:2048
    ds_read_b128 v[76:79], v8 offset:4352
    s_waitcnt lgkmcnt(9)
    v_mfma_f32_16x16x32_bf16 v[128:131], v[80:83], v[64:67], 0
    ds_read_b64_tr_b16 v[112:113], v9 offset:8192
    s_waitcnt lgkmcnt(7)
    v_mfma_f32_16x16x32_bf16 v[132:135], v[84:87], v[64:67], 0
    ds_read_b64_tr_b16 v[114:115], v9 offset:10240
    v_mfma_f32_16x16x32_bf16 v[144:147], v[80:83], v[68:71], 0
    ds_read_b128 v[96:99], v8 offset:2048
    v_mfma_f32_16x16x32_bf16 v[148:151], v[84:87], v[68:71], 0
    ds_read_b64_tr_b16 v[116:117], v10 offset:8192
    s_waitcnt lgkmcnt(7)
    v_mfma_f32_16x16x32_bf16 v[136:139], v[88:91], v[64:67], 0
    ds_read_b64_tr_b16 v[118:119], v10 offset:10240
    v_mfma_f32_16x16x32_bf16 v[152:155], v[88:91], v[68:71], 0
    ds_read_b128 v[100:103], v8 offset:2304
    v_mfma_f32_16x16x32_bf16 v[160:163], v[80:83], v[72:75], 0
    ds_read_b64_tr_b16 v[120:121], v11 offset:8192
    v_mfma_f32_16x16x32_bf16 v[164:167], v[84:87], v[72:75], 0
    ds_read_b64_tr_b16 v[122:123], v11 offset:10240
    v_mfma_f32_16x16x32_bf16 v[168:171], v[88:91], v[72:75], 0
    ds_read_b128 v[104:107], v8 offset:6144
    s_waitcnt lgkmcnt(9)
    v_mfma_f32_16x16x32_bf16 v[140:143], v[92:95], v[64:67], 0
    ds_read_b64_tr_b16 v[124:125], v12 offset:8192
    v_mfma_f32_16x16x32_bf16 v[156:159], v[92:95], v[68:71], 0
    ds_read_b64_tr_b16 v[126:127], v12 offset:10240
    v_mfma_f32_16x16x32_bf16 v[172:175], v[92:95], v[72:75], 0
    ds_read_b128 v[108:111], v8 offset:6400
    v_mfma_f32_16x16x32_bf16 v[176:179], v[80:83], v[76:79], 0
    v_mfma_f32_16x16x32_bf16 v[180:183], v[84:87], v[76:79], 0
    v_mfma_f32_16x16x32_bf16 v[184:187], v[88:91], v[76:79], 0
    v_mfma_f32_16x16x32_bf16 v[188:191], v[92:95], v[76:79], 0
    s_branch KF_PCL_E
.p2align 6
KF_PCL:
    s_waitcnt lgkmcnt(9)
    v_mfma_f32_16x16x32_bf16 v[128:131], v[112:115], v[96:99], v[128:131]
    s_waitcnt lgkmcnt(6)
    v_mfma_f32_16x16x32_bf16 v[132:135], v[116:119], v[96:99], v[132:135]
    v_mfma_f32_16x16x32_bf16 v[144:147], v[112:115], v[100:103], v[144:147]
    v_mfma_f32_16x16x32_bf16 v[148:151], v[116:119], v[100:103], v[148:151]
    s_waitcnt lgkmcnt(0)
    s_barrier
    v_mfma_f32_16x16x32_bf16 v[136:139], v[120:123], v[96:99], v[136:139]
    ds_read_b64_tr_b16 v[80:81], v9 offset:0
    v_mfma_f32_16x16x32_bf16 v[152:155], v[120:123], v[100:103], v[152:155]
    ds_read_b64_tr_b16 v[82:83], v9 offset:2048
    v_mfma_f32_16x16x32_bf16 v[160:163], v[112:115], v[104:107], v[160:163]
    ds_read_b128 v[64:67], v8 offset:0
    v_mfma_f32_16x16x32_bf16 v[164:167], v[116:119], v[104:107], v[164:167]
    ds_read_b64_tr_b16 v[84:85], v10 offset:0
    v_mfma_f32_16x16x32_bf16 v[168:171], v[120:123], v[104:107], v[168:171]
    ds_read_b64_tr_b16 v[86:87], v10 offset:2048
    v_mfma_f32_16x16x32_bf16 v[140:143], v[124:127], v[96:99], v[140:143]
    ds_read_b128 v[68:71], v8 offset:256
    v_mfma_f32_16x16x32_bf16 v[156:159], v[124:127], v[100:103], v[156:159]
    ds_read_b64_tr_b16 v[88:89], v11 offset:0
    v_mfma_f32_16x16x32_bf16 v[172:175], v[124:127], v[104:107], v[172:175]
    ds_read_b64_tr_b16 v[90:91], v11 offset:2048
    v_mfma_f32_16x16x32_bf16 v[176:179], v[112:115], v[108:111], v[176:179]
    ds_read_b128 v[72:75], v8 offset:4096
    v_mfma_f32_16x16x32_bf16 v[180:183], v[116:119], v[108:111], v[180:183]
    ds_read_b64_tr_b16 v[92:93], v12 offset:0
    v_mfma_f32_16x16x32_bf16 v[184:187], v[120:123], v[108:111], v[184:187]
    ds_read_b64_tr_b16 v[94:95], v12 offset:2048
    v_mfma_f32_16x16x32_bf16 v[188:191], v[124:127], v[108:111], v[188:191]
    ds_read_b128 v[76:79], v8 offset:4352
    s_waitcnt lgkmcnt(9)
    v_mfma_f32_16x16x32_bf16 v[128:131], v[80:83], v[64:67], v[128:131]
    ds_read_b64_tr_b16 v[112:113], v9 offset:8192
    s_waitcnt lgkmcnt(7)
    v_mfma_f32_16x16x32_bf16 v[132:135], v[84:87], v[64:67], v[132:135]
    ds_read_b64_tr_b16 v[114:115], v9 offset:10240
    v_mfma_f32_16x16x32_bf16 v[144:147], v[80:83], v[68:71], v[144:147]
    ds_read_b128 v[96:99], v8 offset:2048
    v_mfma_f32_16x16x32_bf16 v[148:151], v[84:87], v[68:71], v[148:151]
    ds_read_b64_tr_b16 v[116:117], v10 offset:8192
    s_waitcnt lgkmcnt(7)
    v_mfma_f32_16x16x32_bf16 v[136:139], v[88:91], v[64:67], v[136:139]
    ds_read_b64_tr_b16 v[118:119], v10 offset:10240
    v_mfma_f32_16x16x32_bf16 v[152:155], v[88:91], v[68:71], v[152:155]
    ds_read_b128 v[100:103], v8 offset:2304
    v_mfma_f32_16x16x32_bf16 v[160:163], v[80:83], v[72:75], v[160:163]
    ds_read_b64_tr_b16 v[120:121], v11 offset:8192
    v_mfma_f32_16x16x32_bf16 v[164:167], v[84:87], v[72:75], v[164:167]
    ds_read_b64_tr_b16 v[122:123], v11 offset:10240
    v_mfma_f32_16x16x32_bf16 v[168:171], v[88:91], v[72:75], v[168:171]
    ds_read_b128 v[104:107], v8 offset:6144
    s_waitcnt lgkmcnt(9)
    v_mfma_f32_16x16x32_bf16 v[140:143], v[92:95], v[64:67], v[140:143]
    ds_read_b64_tr_b16 v[124:125], v12 offset:8192
    v_mfma_f32_16x16x32_bf16 v[156:159], v[92:95], v[68:71], v[156:159]
    ds_read_b64_tr_b16 v[126:127], v12 offset:10240
    v_mfma_f32_16x16x32_bf16 v[172:175], v[92:95], v[72:75], v[172:175]
    ds_read_b128 v[108:111], v8 offset:6400
    v_mfma_f32_16x16x32_bf16 v[176:179], v[80:83], v[76:79], v[176:179]
    v_mfma_f32_16x16x32_bf16 v[180:183], v[84:87], v[76:79], v[180:183]
    v_mfma_f32_16x16x32_bf16 v[184:187], v[88:91], v[76:79], v[184:187]
    v_mfma_f32_16x16x32_bf16 v[188:191], v[92:95], v[76:79], v[188:191]
KF_PCL_E:
    s_waitcnt lgkmcnt(9)
    v_mfma_f32_16x16x32_bf16 v[128:131], v[112:115], v[96:99], v[128:131]
    s_waitcnt lgkmcnt(6)
    v_mfma_f32_16x16x32_bf16 v[132:135], v[116:119], v[96:99], v[132:135]
    v_mfma_f32_16x16x32_bf16 v[144:147], v[112:115], v[100:103], v[144:147]
    v_mfma_f32_16x16x32_bf16 v[148:151], v[116:119], v[100:103], v[148:151]
    s_waitcnt lgkmcnt(0)
    s_barrier
    v_mfma_f32_16x16x32_bf16 v[136:139], v[120:123], v[96:99], v[136:139]
    ds_read_b64_tr_b16 v[80:81], v9 offset:32768
    v_mfma_f32_16x16x32_bf16 v[152:155], v[120:123], v[100:103], v[152:155]
    ds_read_b64_tr_b16 v[82:83], v9 offset:34816
    v_mfma_f32_16x16x32_bf16 v[160:163], v[112:115], v[104:107], v[160:163]
    ds_read_b128 v[64:67], v8 offset:32768
    v_mfma_f32_16x16x32_bf16 v[164:167], v[116:119], v[104:107], v[164:167]
    ds_read_b64_tr_b16 v[84:85], v10 offset:32768
    v_mfma_f32_16x16x32_bf16 v[168:171], v[120:123], v[104:107], v[168:171]
    ds_read_b64_tr_b16 v[86:87], v10 offset:34816
    v_mfma_f32_16x16x32_bf16 v[140:143], v[124:127], v[96:99], v[140:143]
    ds_read_b128 v[68:71], v8 offset:33024
    v_mfma_f32_16x16x32_bf16 v[156:159], v[124:127], v[100:103], v[156:159]
    ds_read_b64_tr_b16 v[88:89], v11 offset:32768
    v_mfma_f32_16x16x32_bf16 v[172:175], v[124:127], v[104:107], v[172:175]
    ds_read_b64_tr_b16 v[90:91], v11 offset:34816
    v_mfma_f32_16x16x32_bf16 v[176:179], v[112:115], v[108:111], v[176:179]
    ds_read_b128 v[72:75], v8 offset:36864
    v_mfma_f32_16x16x32_bf16 v[180:183], v[116:119], v[108:111], v[180:183]
    ds_read_b64_tr_b16 v[92:93], v12 offset:32768
    v_mfma_f32_16x16x32_bf16 v[184:187], v[120:123], v[108:111], v[184:187]
    ds_read_b64_tr_b16 v[94:95], v12 offset:34816
    v_mfma_f32_16x16x32_bf16 v[188:191], v[124:127], v[108:111], v[188:191]
    ds_read_b128 v[76:79], v8 offset:37120
    s_waitcnt lgkmcnt(9)
    v_mfma_f32_16x16x32_bf16 v[128:131], v[80:83], v[64:67], v[128:131]
    ds_read_b64_tr_b16 v[112:113], v9 offset:40960
    s_waitcnt lgkmcnt(7)
    v_mfma_f32_16x16x32_bf16 v[132:135], v[84:87], v[64:67], v[132:135]
    ds_read_b64_tr_b16 v[114:115], v9 offset:43008
    v_mfma_f32_16x16x32_bf16 v[144:147], v[80:83], v[68:71], v[144:147]
    ds_read_b128 v[96:99], v8 offset:34816
    v_mfma_f32_16x16x32_bf16 v[148:151], v[84:87], v[68:71], v[148:151]
    ds_read_b64_tr_b16 v[116:117], v10 offset:40960
    s_waitcnt lgkmcnt(7)
    v_mfma_f32_16x16x32_bf16 v[136:139], v[88:91], v[64:67], v[136:139]
    ds_read_b64_tr_b16 v[118:119], v10 offset:43008
    v_mfma_f32_16x16x32_bf16 v[152:155], v[88:91], v[68:71], v[152:155]
    ds_read_b128 v[100:103], v8 offset:35072
    v_mfma_f32_16x16x32_bf16 v[160:163], v[80:83], v[72:75], v[160:163]
    ds_read_b64_tr_b16 v[120:121], v11 offset:40960
    v_mfma_f32_16x16x32_bf16 v[164:167], v[84:87], v[72:75], v[164:167]
    ds_read_b64_tr_b16 v[122:123], v11 offset:43008
    v_mfma_f32_16x16x32_bf16 v[168:171], v[88:91], v[72:75], v[168:171]
    ds_read_b128 v[104:107], v8 offset:38912
    s_waitcnt lgkmcnt(9)
    v_mfma_f32_16x16x32_bf16 v[140:143], v[92:95], v[64:67], v[140:143]
    ds_read_b64_tr_b16 v[124:125], v12 offset:40960
    v_mfma_f32_16x16x32_bf16 v[156:159], v[92:95], v[68:71], v[156:159]
    ds_read_b64_tr_b16 v[126:127], v12 offset:43008
    v_mfma_f32_16x16x32_bf16 v[172:175], v[92:95], v[72:75], v[172:175]
    ds_read_b128 v[108:111], v8 offset:39168
    v_mfma_f32_16x16x32_bf16 v[176:179], v[80:83], v[76:79], v[176:179]
    v_mfma_f32_16x16x32_bf16 v[180:183], v[84:87], v[76:79], v[180:183]
    v_mfma_f32_16x16x32_bf16 v[184:187], v[88:91], v[76:79], v[184:187]
    v_mfma_f32_16x16x32_bf16 v[188:191], v[92:95], v[76:79], v[188:191]
    s_waitcnt lgkmcnt(9)
    v_mfma_f32_16x16x32_bf16 v[128:131], v[112:115], v[96:99], v[128:131]
    s_waitcnt lgkmcnt(6)
    v_mfma_f32_16x16x32_bf16 v[132:135], v[116:119], v[96:99], v[132:135]
    v_mfma_f32_16x16x32_bf16 v[144:147], v[112:115], v[100:103], v[144:147]
    v_mfma_f32_16x16x32_bf16 v[148:151], v[116:119], v[100:103], v[148:151]
    s_waitcnt lgkmcnt(0)
    s_barrier
    v_mfma_f32_16x16x32_bf16 v[136:139], v[120:123], v[96:99], v[136:139]
    ds_read_b64_tr_b16 v[80:81], v14 offset:0
    v_mfma_f32_16x16x32_bf16 v[152:155], v[120:123], v[100:103], v[152:155]
    ds_read_b64_tr_b16 v[82:83], v14 offset:2048
    v_mfma_f32_16x16x32_bf16 v[160:163], v[112:115], v[104:107], v[160:163]
    ds_read_b128 v[64:67], v13 offset:0
    v_mfma_f32_16x16x32_bf16 v[164:167], v[116:119], v[104:107], v[164:167]
    ds_read_b64_tr_b16 v[84:85], v15 offset:0
    v_mfma_f32_16x16x32_bf16 v[168:171], v[120:123], v[104:107], v[168:171]
    ds_read_b64_tr_b16 v[86:87], v15 offset:2048
    v_mfma_f32_16x16x32_bf16 v[140:143], v[124:127], v[96:99], v[140:143]
    ds_read_b128 v[68:71], v13 offset:256
    v_mfma_f32_16x16x32_bf16 v[156:159], v[124:127], v[100:103], v[156:159]
    ds_read_b64_tr_b16 v[88:89], v16 offset:0
    v_mfma_f32_16x16x32_bf16 v[172:175], v[124:127], v[104:107], v[172:175]
    ds_read_b64_tr_b16 v[90:91], v16 offset:2048
    v_mfma_f32_16x16x32_bf16 v[176:179], v[112:115], v[108:111], v[176:179]
    ds_read_b128 v[72:75], v13 offset:4096
    v_mfma_f32_16x16x32_bf16 v[180:183], v[116:119], v[108:111], v[180:183]
    ds_read_b64_tr_b16 v[92:93], v17 offset:0
    v_mfma_f32_16x16x32_bf16 v[184:187], v[120:123], v[108:111], v[184:187]
    ds_read_b64_tr_b16 v[94:95], v17 offset:2048
    v_mfma_f32_16x16x32_bf16 v[188:191], v[124:127], v[108:111], v[188:191]
    ds_read_b128 v[76:79], v13 offset:4352
    s_waitcnt lgkmcnt(9)
    v_mfma_f32_16x16x32_bf16 v[128:131], v[80:83], v[64:67], v[128:131]
    ds_read_b64_tr_b16 v[112:113], v14 offset:8192
    s_waitcnt lgkmcnt(7)
    v_mfma_f32_16x16x32_bf16 v[132:135], v[84:87], v[64:67], v[132:135]
    ds_read_b64_tr_b16 v[114:115], v14 offset:10240
    v_mfma_f32_16x16x32_bf16 v[144:147], v[80:83], v[68:71], v[144:147]
    ds_read_b128 v[96:99], v13 offset:2048
    v_mfma_f32_16x16x32_bf16 v[148:151], v[84:87], v[68:71], v[148:151]
    ds_read_b64_tr_b16 v[116:117], v15 offset:8192
    s_waitcnt lgkmcnt(7)
    v_mfma_f32_16x16x32_bf16 v[136:139], v[88:91], v[64:67], v[136:139]
    ds_read_b64_tr_b16 v[118:119], v15 offset:10240
    v_mfma_f32_16x16x32_bf16 v[152:155], v[88:91], v[68:71], v[152:155]
    ds_read_b128 v[100:103], v13 offset:2304
    v_mfma_f32_16x16x32_bf16 v[160:163], v[80:83], v[72:75], v[160:163]
    ds_read_b64_tr_b16 v[120:121], v16 offset:8192
    v_mfma_f32_16x16x32_bf16 v[164:167], v[84:87], v[72:75], v[164:167]
    ds_read_b64_tr_b16 v[122:123], v16 offset:10240
    v_mfma_f32_16x16x32_bf16 v[168:171], v[88:91], v[72:75], v[168:171]
    ds_read_b128 v[104:107], v13 offset:6144
    s_waitcnt lgkmcnt(9)
    v_mfma_f32_16x16x32_bf16 v[140:143], v[92:95], v[64:67], v[140:143]
    ds_read_b64_tr_b16 v[124:125], v17 offset:8192
    v_mfma_f32_16x16x32_bf16 v[156:159], v[92:95], v[68:71], v[156:159]
    ds_read_b64_tr_b16 v[126:127], v17 offset:10240
    v_mfma_f32_16x16x32_bf16 v[172:175], v[92:95], v[72:75], v[172:175]
    ds_read_b128 v[108:111], v13 offset:6400
    v_mfma_f32_16x16x32_bf16 v[176:179], v[80:83], v[76:79], v[176:179]
    v_mfma_f32_16x16x32_bf16 v[180:183], v[84:87], v[76:79], v[180:183]
    v_mfma_f32_16x16x32_bf16 v[184:187], v[88:91], v[76:79], v[184:187]
    v_mfma_f32_16x16x32_bf16 v[188:191], v[92:95], v[76:79], v[188:191]
    s_waitcnt lgkmcnt(9)
    v_mfma_f32_16x16x32_bf16 v[128:131], v[112:115], v[96:99], v[128:131]
    s_waitcnt lgkmcnt(6)
    v_mfma_f32_16x16x32_bf16 v[132:135], v[116:119], v[96:99], v[132:135]
    v_mfma_f32_16x16x32_bf16 v[144:147], v[112:115], v[100:103], v[144:147]
    v_mfma_f32_16x16x32_bf16 v[148:151], v[116:119], v[100:103], v[148:151]
    s_waitcnt lgkmcnt(0)
    s_barrier
    v_mfma_f32_16x16x32_bf16 v[136:139], v[120:123], v[96:99], v[136:139]
    ds_read_b64_tr_b16 v[80:81], v14 offset:32768
    v_mfma_f32_16x16x32_bf16 v[152:155], v[120:123], v[100:103], v[152:155]
    ds_read_b64_tr_b16 v[82:83], v14 offset:34816
    v_mfma_f32_16x16x32_bf16 v[160:163], v[112:115], v[104:107], v[160:163]
    ds_read_b128 v[64:67], v13 offset:32768
    v_mfma_f32_16x16x32_bf16 v[164:167], v[116:119], v[104:107], v[164:167]
    ds_read_b64_tr_b16 v[84:85], v15 offset:32768
    v_mfma_f32_16x16x32_bf16 v[168:171], v[120:123], v[104:107], v[168:171]
    ds_read_b64_tr_b16 v[86:87], v15 offset:34816
    v_mfma_f32_16x16x32_bf16 v[140:143], v[124:127], v[96:99], v[140:143]
    ds_read_b128 v[68:71], v13 offset:33024
    v_mfma_f32_16x16x32_bf16 v[156:159], v[124:127], v[100:103], v[156:159]
    ds_read_b64_tr_b16 v[88:89], v16 offset:32768
    v_mfma_f32_16x16x32_bf16 v[172:175], v[124:127], v[104:107], v[172:175]
    ds_read_b64_tr_b16 v[90:91], v16 offset:34816
    v_mfma_f32_16x16x32_bf16 v[176:179], v[112:115], v[108:111], v[176:179]
    ds_read_b128 v[72:75], v13 offset:36864
    v_mfma_f32_16x16x32_bf16 v[180:183], v[116:119], v[108:111], v[180:183]
    ds_read_b64_tr_b16 v[92:93], v17 offset:32768
    v_mfma_f32_16x16x32_bf16 v[184:187], v[120:123], v[108:111], v[184:187]
    ds_read_b64_tr_b16 v[94:95], v17 offset:34816
    v_mfma_f32_16x16x32_bf16 v[188:191], v[124:127], v[108:111], v[188:191]
    ds_read_b128 v[76:79], v13 offset:37120
    s_waitcnt lgkmcnt(9)
    v_mfma_f32_16x16x32_bf16 v[128:131], v[80:83], v[64:67], v[128:131]
    ds_read_b64_tr_b16 v[112:113], v14 offset:40960
    s_waitcnt lgkmcnt(7)
    v_mfma_f32_16x16x32_bf16 v[132:135], v[84:87], v[64:67], v[132:135]
    ds_read_b64_tr_b16 v[114:115], v14 offset:43008
    v_mfma_f32_16x16x32_bf16 v[144:147], v[80:83], v[68:71], v[144:147]
    ds_read_b128 v[96:99], v13 offset:34816
    v_mfma_f32_16x16x32_bf16 v[148:151], v[84:87], v[68:71], v[148:151]
    ds_read_b64_tr_b16 v[116:117], v15 offset:40960
    s_waitcnt lgkmcnt(7)
    v_mfma_f32_16x16x32_bf16 v[136:139], v[88:91], v[64:67], v[136:139]
    ds_read_b64_tr_b16 v[118:119], v15 offset:43008
    v_mfma_f32_16x16x32_bf16 v[152:155], v[88:91], v[68:71], v[152:155]
    ds_read_b128 v[100:103], v13 offset:35072
    v_mfma_f32_16x16x32_bf16 v[160:163], v[80:83], v[72:75], v[160:163]
    ds_read_b64_tr_b16 v[120:121], v16 offset:40960
    v_mfma_f32_16x16x32_bf16 v[164:167], v[84:87], v[72:75], v[164:167]
    ds_read_b64_tr_b16 v[122:123], v16 offset:43008
    v_mfma_f32_16x16x32_bf16 v[168:171], v[88:91], v[72:75], v[168:171]
    ds_read_b128 v[104:107], v13 offset:38912
    s_waitcnt lgkmcnt(9)
    v_mfma_f32_16x16x32_bf16 v[140:143], v[92:95], v[64:67], v[140:143]
    ds_read_b64_tr_b16 v[124:125], v17 offset:40960
    v_mfma_f32_16x16x32_bf16 v[156:159], v[92:95], v[68:71], v[156:159]
    ds_read_b64_tr_b16 v[126:127], v17 offset:43008
    v_mfma_f32_16x16x32_bf16 v[172:175], v[92:95], v[72:75], v[172:175]
    ds_read_b128 v[108:111], v13 offset:39168
    v_mfma_f32_16x16x32_bf16 v[176:179], v[80:83], v[76:79], v[176:179]
    v_mfma_f32_16x16x32_bf16 v[180:183], v[84:87], v[76:79], v[180:183]
    v_mfma_f32_16x16x32_bf16 v[184:187], v[88:91], v[76:79], v[184:187]
    v_mfma_f32_16x16x32_bf16 v[188:191], v[92:95], v[76:79], v[188:191]
    s_sub_u32 s10, s10, 1
    s_cmp_lg_u32 s10, 0
    s_cbranch_scc1 KF_PCL
    s_waitcnt lgkmcnt(0)
    v_mfma_f32_16x16x32_bf16 v[128:131], v[112:115], v[96:99], v[128:131]
    v_mfma_f32_16x16x32_bf16 v[132:135], v[116:119], v[96:99], v[132:135]
    v_mfma_f32_16x16x32_bf16 v[136:139], v[120:123], v[96:99], v[136:139]
    v_mfma_f32_16x16x32_bf16 v[140:143], v[124:127], v[96:99], v[140:143]
    v_mfma_f32_16x16x32_bf16 v[144:147], v[112:115], v[100:103], v[144:147]
    v_mfma_f32_16x16x32_bf16 v[148:151], v[116:119], v[100:103], v[148:151]
    v_mfma_f32_16x16x32_bf16 v[152:155], v[120:123], v[100:103], v[152:155]
    v_mfma_f32_16x16x32_bf16 v[156:159], v[124:127], v[100:103], v[156:159]
    v_mfma_f32_16x16x32_bf16 v[160:163], v[112:115], v[104:107], v[160:163]
    v_cvt_pk_bf16_f32 v128, v128, v129
    v_cvt_pk_bf16_f32 v129, v130, v131
    ds_write_b64 v2, v[128:129] offset:0
    v_cvt_pk_bf16_f32 v132, v132, v133
    v_mfma_f32_16x16x32_bf16 v[164:167], v[116:119], v[104:107], v[164:167]
    v_cvt_pk_bf16_f32 v133, v134, v135
    ds_write_b64 v2, v[132:133] offset:32
    v_cvt_pk_bf16_f32 v136, v136, v137
    v_cvt_pk_bf16_f32 v137, v138, v139
    v_mfma_f32_16x16x32_bf16 v[168:171], v[120:123], v[104:107], v[168:171]
    ds_write_b64 v2, v[136:137] offset:64
    v_cvt_pk_bf16_f32 v140, v140, v141
    v_cvt_pk_bf16_f32 v141, v142, v143
    ds_write_b64 v2, v[140:141] offset:96
    v_mfma_f32_16x16x32_bf16 v[172:175], v[124:127], v[104:107], v[172:175]
    ds_read_b128 v[64:67], v6 offset:0
    ds_read_b128 v[68:71], v6 offset:1152
    v_mfma_f32_16x16x32_bf16 v[176:179], v[112:115], v[108:111], v[176:179]
    v_cvt_pk_bf16_f32 v144, v144, v145
    v_cvt_pk_bf16_f32 v145, v146, v147
    ds_write_b64 v2, v[144:145] offset:2304
    v_cvt_pk_bf16_f32 v148, v148, v149
    v_mfma_f32_16x16x32_bf16 v[180:183], v[116:119], v[108:111], v[180:183]
    v_cvt_pk_bf16_f32 v149, v150, v151
    ds_write_b64 v2, v[148:149] offset:2336
    v_cvt_pk_bf16_f32 v152, v152, v153
    v_cvt_pk_bf16_f32 v153, v154, v155
    v_mfma_f32_16x16x32_bf16 v[184:187], v[120:123], v[108:111], v[184:187]
    ds_write_b64 v2, v[152:153] offset:2368
    v_cvt_pk_bf16_f32 v156, v156, v157
    v_cvt_pk_bf16_f32 v157, v158, v159
    ds_write_b64 v2, v[156:157] offset:2400
    v_mfma_f32_16x16x32_bf16 v[188:191], v[124:127], v[108:111], v[188:191]
    ds_read_b128 v[72:75], v6 offset:2304
    ds_read_b128 v[76:79], v6 offset:3456
    v_cvt_pk_bf16_f32 v160, v160, v161
    v_cvt_pk_bf16_f32 v161, v162, v163
    ds_write_b64 v2, v[160:161] offset:4608
    v_cvt_pk_bf16_f32 v164, v164, v165
    v_cvt_pk_bf16_f32 v165, v166, v167
    ds_write_b64 v2, v[164:165] offset:4640
    v_cvt_pk_bf16_f32 v168, v168, v169
    v_cvt_pk_bf16_f32 v169, v170, v171
    ds_write_b64 v2, v[168:169] offset:4672
    v_cvt_pk_bf16_f32 v172, v172, v173
    v_cvt_pk_bf16_f32 v173, v174, v175
    ds_write_b64 v2, v[172:173] offset:4704
    ds_read_b128 v[80:83], v6 offset:4608
    ds_read_b128 v[84:87], v6 offset:5760
    s_waitcnt lgkmcnt(6)
    buffer_store_dwordx4 v[64:67], v7, s[28:31], s11 offen sc0 sc1
    s_add_u32 s11, s11, 32768
    buffer_store_dwordx4 v[68:71], v7, s[28:31], s11 offen sc0 sc1
    s_add_u32 s11, s11, 32768
    buffer_store_dwordx4 v[72:75], v7, s[28:31], s11 offen sc0 sc1
    s_add_u32 s11, s11, 32768
    buffer_store_dwordx4 v[76:79], v7, s[28:31], s11 offen sc0 sc1
    s_add_u32 s11, s11, 32768
    v_cvt_pk_bf16_f32 v176, v176, v177
    v_cvt_pk_bf16_f32 v177, v178, v179
    ds_write_b64 v2, v[176:177] offset:6912
    v_cvt_pk_bf16_f32 v180, v180, v181
    v_cvt_pk_bf16_f32 v181, v182, v183
    ds_write_b64 v2, v[180:181] offset:6944
    v_cvt_pk_bf16_f32 v184, v184, v185
    v_cvt_pk_bf16_f32 v185, v186, v187
    ds_write_b64 v2, v[184:185] offset:6976
    v_cvt_pk_bf16_f32 v188, v188, v189
    v_cvt_pk_bf16_f32 v189, v190, v191
    ds_write_b64 v2, v[188:189] offset:7008
    ds_read_b128 v[88:91], v6 offset:6912
    ds_read_b128 v[92:95], v6 offset:8064
    s_waitcnt lgkmcnt(6)
    buffer_store_dwordx4 v[80:83], v7, s[28:31], s11 offen sc0 sc1
    s_add_u32 s11, s11, 32768
    buffer_store_dwordx4 v[84:87], v7, s[28:31], s11 offen sc0 sc1
    s_add_u32 s11, s11, 32768
    s_waitcnt lgkmcnt(0)
    buffer_store_dwordx4 v[88:91], v7, s[28:31], s11 offen sc0 sc1
    s_add_u32 s11, s11, 32768
    buffer_store_dwordx4 v[92:95], v7, s[28:31], s11 offen sc0 sc1
    s_add_u32 s11, s11, 32768
    s_endpgm
KF_PL:
    s_setprio 3
    s_mov_b32 s14, 0
    s_waitcnt vmcnt(0) lgkmcnt(0)
    v_mov_b32 v16, 1
    s_mov_b64 exec, 1
    buffer_store_dword v16, v12, s[52:55], s95 offen sc0 sc1
    s_mov_b64 exec, -1
    s_lshl_b32 s10, s13, 16
    s_add_u32 s69, s69, s10
    s_mov_b32 s73, 65536
    v_mov_b32 v18, 139264
    s_mov_b32 s15, 0
    s_cmp_lg_u32 s8, 4
    s_cbranch_scc1 KF_PN
    v_cmp_eq_u32 vcc, 1, v15
    v_lshlrev_b32 v16, 2, v0
    v_add_u32 v16, 139264, v16
    v_mov_b32 v17, 0
    ds_write_b32 v16, v17
    s_mov_b32 s66, 0x01010101
    s_mov_b32 s67, 0x01010101
    s_lshl_b32 s10, s3, 3
    s_bitset0_b64 s[66:67], s10
    s_mov_b64 s[18:19], vcc
    s_lshr_b32 s10, s75, 1
    s_and_b32 s9, s10, 4
    s_add_u32 s10, s10, s3
    s_and_b32 s10, s10, 3
    s_xor_b32 s9, s9, s3
    s_and_b32 s9, s9, 4
    s_or_b32 s10, s10, s9
    s_add_u32 s75, s75, 2
    s_lshl_b32 s10, s10, 3
    s_lshl_b64 s[66:67], 1, s10
    s_lshr_b64 s[10:11], s[18:19], 4
    s_and_b64 s[10:11], s[10:11], s[18:19]
    s_lshr_b64 s[12:13], s[10:11], 2
    s_and_b64 s[10:11], s[10:11], s[12:13]
    s_lshr_b64 s[12:13], s[10:11], 1
    s_and_b64 s[10:11], s[10:11], s[12:13]
    s_and_b64 s[10:11], s[10:11], s[66:67]
    s_cbranch_scc0 KF_PN
    s_ff1_i32_b64 s10, s[10:11]
    s_bitset0_b64 s[66:67], s10
    s_lshr_b32 s74, s10, 2
    s_lshr_b32 s11, s10, 3
    s_add_u32 s11, s11, 1
    v_mov_b32 v17, s11
    ds_write_b32 v18, v17
    v_add_u32 v18, 4, v18
    s_lshr_b32 s10, s75, 1
    s_and_b32 s9, s10, 4
    s_add_u32 s10, s10, s3
    s_and_b32 s10, s10, 3
    s_xor_b32 s9, s9, s3
    s_and_b32 s9, s9, 4
    s_or_b32 s10, s10, s9
    s_add_u32 s75, s75, 2
    s_lshl_b32 s10, s10, 3
    s_lshl_b64 s[66:67], 1, s10
    s_mov_b32 s15, 1
KF_PN:
    s_waitcnt lgkmcnt(0)
    s_barrier
    s_lshr_b32 s11, 2, 1
    s_and_b32 s9, s11, 4
    s_add_u32 s11, s11, s3
    s_and_b32 s11, s11, 3
    s_xor_b32 s9, s9, s3
    s_and_b32 s9, s9, 4
    s_or_b32 s11, s11, s9
    s_lshl_b32 s11, s11, 1
    s_lshl_b32 s12, s11, 17
    s_add_u32 s12, s12, s70
    s_add_u32 m0, s71, 65536
    s_add_u32 m0, m0, 16384
    s_nop 0
    buffer_load_dwordx4 v10, s[24:27], s12 offen lds
    s_add_u32 m0, m0, 1024
    s_add_u32 s12, s12, 8192
    buffer_load_dwordx4 v11, s[24:27], s12 offen lds
    s_add_u32 m0, m0, 1024
    s_add_u32 s12, s12, 8192
    buffer_load_dwordx4 v10, s[24:27], s12 offen lds
    s_add_u32 m0, m0, 1024
    s_add_u32 s12, s12, 8192
    buffer_load_dwordx4 v11, s[24:27], s12 offen lds
    s_add_u32 s11, s11, 1
    s_lshl_b32 s12, s11, 17
    s_add_u32 s12, s12, s70
    s_add_u32 m0, s71, 98304
    s_add_u32 m0, m0, 16384
    s_nop 0
    buffer_load_dwordx4 v10, s[24:27], s12 offen lds
    s_add_u32 m0, m0, 1024
    s_add_u32 s12, s12, 8192
    buffer_load_dwordx4 v11, s[24:27], s12 offen lds
    s_add_u32 m0, m0, 1024
    s_add_u32 s12, s12, 8192
    buffer_load_dwordx4 v10, s[24:27], s12 offen lds
    s_add_u32 m0, m0, 1024
    s_add_u32 s12, s12, 8192
    buffer_load_dwordx4 v11, s[24:27], s12 offen lds
    s_cmp_eq_u32 s15, 1
    s_cbranch_scc1 KF_PA
    s_cmp_eq_u32 s8, 4
    s_cbranch_scc1 KF_PB
    ds_read_b32 v17, v18
    s_waitcnt lgkmcnt(0)
    v_readfirstlane_b32 s10, v17
    s_nop 0
    s_cmp_eq_u32 s10, 0
    s_cbranch_scc1 KF_PB2
    v_add_u32 v18, 4, v18
    s_sub_u32 s10, s10, 1
    s_lshl_b32 s74, s10, 1
KF_PA:
    s_lshl_b32 s12, s74, 12
    s_add_u32 s12, s12, s69
    s_add_u32 m0, s71, s73
    s_nop 0
    buffer_load_dwordx4 v1, s[52:55], s12 offen offset:0 sc1 lds
    buffer_load_dwordx4 v1, s[52:55], s12 offen offset:1024 sc1 lds
    buffer_load_dwordx4 v1, s[52:55], s12 offen offset:2048 sc1 lds
    buffer_load_dwordx4 v1, s[52:55], s12 offen offset:3072 sc1 lds
    s_add_u32 s74, s74, 1
    s_add_u32 s73, s73, 32768
    s_and_b32 s73, s73, 131071
    s_lshl_b32 s12, s74, 12
    s_add_u32 s12, s12, s69
    s_add_u32 m0, s71, s73
    s_nop 0
    buffer_load_dwordx4 v1, s[52:55], s12 offen offset:0 sc1 lds
    buffer_load_dwordx4 v1, s[52:55], s12 offen offset:1024 sc1 lds
    buffer_load_dwordx4 v1, s[52:55], s12 offen offset:2048 sc1 lds
    buffer_load_dwordx4 v1, s[52:55], s12 offen offset:3072 sc1 lds
    s_add_u32 s74, s74, 1
    s_add_u32 s73, s73, 32768
    s_and_b32 s73, s73, 131071
    s_barrier
    s_branch KF_PC2
KF_PB:
    buffer_load_dword v17, v14, s[52:55], s95 offen sc0 sc1
    s_barrier
    s_add_u32 s14, s14, 1
    s_waitcnt vmcnt(0)
    v_cmp_eq_u32 vcc, 1, v17
    s_cmp_gt_u32 s14, 0x40000
    s_cselect_b64 s[18:19], -1, vcc
    s_branch KF_PB3
KF_PB2:
    s_barrier
KF_PB3:
    s_cmp_lg_u32 s8, 4
    s_cbranch_scc1 KF_PF_13
    s_branch KF_PQ_15
KF_PR_16:
    buffer_load_dword v17, v14, s[52:55], s95 offen sc0 sc1
    s_add_u32 s14, s14, 1
    s_waitcnt vmcnt(0)
    v_cmp_eq_u32 vcc, 1, v17
    s_cmp_gt_u32 s14, 0x40000
    s_cselect_b64 s[18:19], -1, vcc
KF_PQ_15:
    s_lshr_b64 s[10:11], s[18:19], 4
    s_and_b64 s[10:11], s[10:11], s[18:19]
    s_lshr_b64 s[12:13], s[10:11], 2
    s_and_b64 s[10:11], s[10:11], s[12:13]
    s_lshr_b64 s[12:13], s[10:11], 1
    s_and_b64 s[10:11], s[10:11], s[12:13]
    s_and_b64 s[10:11], s[10:11], s[66:67]
    s_cbranch_scc0 KF_PR_16
    s_ff1_i32_b64 s10, s[10:11]
    s_bitset0_b64 s[66:67], s10
    s_lshr_b32 s74, s10, 2
    s_lshr_b32 s11, s10, 3
    s_add_u32 s11, s11, 1
    v_mov_b32 v17, s11
    ds_write_b32 v18, v17
    v_add_u32 v18, 4, v18
    s_lshr_b32 s10, s75, 1
    s_and_b32 s9, s10, 4
    s_add_u32 s10, s10, s3
    s_and_b32 s10, s10, 3
    s_xor_b32 s9, s9, s3
    s_and_b32 s9, s9, 4
    s_or_b32 s10, s10, s9
    s_add_u32 s75, s75, 2
    s_lshl_b32 s10, s10, 3
    s_lshl_b64 s[66:67], 1, s10
    s_branch KF_PG_14
KF_PF_13:
KF_WQ_17:
    ds_read_b32 v17, v18
    s_waitcnt lgkmcnt(0)
    v_readfirstlane_b32 s10, v17
    s_nop 0
    s_cmp_eq_u32 s10, 0
    s_cbranch_scc1 KF_WQ_17
    v_add_u32 v18, 4, v18
    s_sub_u32 s10, s10, 1
    s_lshl_b32 s74, s10, 1
KF_PG_14:
    s_lshl_b32 s12, s74, 12
    s_add_u32 s12, s12, s69
    s_add_u32 m0, s71, s73
    s_nop 0
    buffer_load_dwordx4 v1, s[52:55], s12 offen offset:0 sc1 lds
    buffer_load_dwordx4 v1, s[52:55], s12 offen offset:1024 sc1 lds
    buffer_load_dwordx4 v1, s[52:55], s12 offen offset:2048 sc1 lds
    buffer_load_dwordx4 v1, s[52:55], s12 offen offset:3072 sc1 lds
    s_add_u32 s74, s74, 1
    s_add_u32 s73, s73, 32768
    s_and_b32 s73, s73, 131071
    s_lshl_b32 s12, s74, 12
    s_add_u32 s12, s12, s69
    s_add_u32 m0, s71, s73
    s_nop 0
    buffer_load_dwordx4 v1, s[52:55], s12 offen offset:0 sc1 lds
    buffer_load_dwordx4 v1, s[52:55], s12 offen offset:1024 sc1 lds
    buffer_load_dwordx4 v1, s[52:55], s12 offen offset:2048 sc1 lds
    buffer_load_dwordx4 v1, s[52:55], s12 offen offset:3072 sc1 lds
    s_add_u32 s74, s74, 1
    s_add_u32 s73, s73, 32768
    s_and_b32 s73, s73, 131071
KF_PC2:
    s_waitcnt vmcnt(4)
    s_barrier
    s_cmp_lg_u32 s8, 4
    s_cbranch_scc1 KF_PF_18
    s_branch KF_PQ_20
KF_PR_21:
    buffer_load_dword v17, v14, s[52:55], s95 offen sc0 sc1
    s_add_u32 s14, s14, 1
    s_waitcnt vmcnt(0)
    v_cmp_eq_u32 vcc, 1, v17
    s_cmp_gt_u32 s14, 0x40000
    s_cselect_b64 s[18:19], -1, vcc
KF_PQ_20:
    s_lshr_b64 s[10:11], s[18:19], 4
    s_and_b64 s[10:11], s[10:11], s[18:19]
    s_lshr_b64 s[12:13], s[10:11], 2
    s_and_b64 s[10:11], s[10:11], s[12:13]
    s_lshr_b64 s[12:13], s[10:11], 1
    s_and_b64 s[10:11], s[10:11], s[12:13]
    s_and_b64 s[10:11], s[10:11], s[66:67]
    s_cbranch_scc0 KF_PR_21
    s_ff1_i32_b64 s10, s[10:11]
    s_bitset0_b64 s[66:67], s10
    s_lshr_b32 s74, s10, 2
    s_lshr_b32 s11, s10, 3
    s_add_u32 s11, s11, 1
    v_mov_b32 v17, s11
    ds_write_b32 v18, v17
    v_add_u32 v18, 4, v18
    s_lshr_b32 s10, s75, 1
    s_and_b32 s9, s10, 4
    s_add_u32 s10, s10, s3
    s_and_b32 s10, s10, 3
    s_xor_b32 s9, s9, s3
    s_and_b32 s9, s9, 4
    s_or_b32 s10, s10, s9
    s_add_u32 s75, s75, 2
    s_lshl_b32 s10, s10, 3
    s_lshl_b64 s[66:67], 1, s10
    s_branch KF_PG_19
KF_PF_18:
KF_WQ_22:
    ds_read_b32 v17, v18
    s_waitcnt lgkmcnt(0)
    v_readfirstlane_b32 s10, v17
    s_nop 0
    s_cmp_eq_u32 s10, 0
    s_cbranch_scc1 KF_WQ_22
    v_add_u32 v18, 4, v18
    s_sub_u32 s10, s10, 1
    s_lshl_b32 s74, s10, 1
KF_PG_19:
    s_lshl_b32 s12, s74, 12
    s_add_u32 s12, s12, s69
    s_add_u32 m0, s71, s73
    s_nop 0
    buffer_load_dwordx4 v1, s[52:55], s12 offen offset:0 sc1 lds
    buffer_load_dwordx4 v1, s[52:55], s12 offen offset:1024 sc1 lds
    buffer_load_dwordx4 v1, s[52:55], s12 offen offset:2048 sc1 lds
    buffer_load_dwordx4 v1, s[52:55], s12 offen offset:3072 sc1 lds
    s_lshl_b32 s12, s74, 17
    s_add_u32 s12, s12, s70
    s_add_u32 m0, s71, s73
    s_add_u32 m0, m0, 16384
    s_nop 0
    buffer_load_dwordx4 v10, s[24:27], s12 offen lds
    s_add_u32 m0, m0, 1024
    s_add_u32 s12, s12, 8192
    buffer_load_dwordx4 v11, s[24:27], s12 offen lds
    s_add_u32 m0, m0, 1024
    s_add_u32 s12, s12, 8192
    buffer_load_dwordx4 v10, s[24:27], s12 offen lds
    s_add_u32 m0, m0, 1024
    s_add_u32 s12, s12, 8192
    buffer_load_dwordx4 v11, s[24:27], s12 offen lds
    s_add_u32 s74, s74, 1
    s_add_u32 s73, s73, 32768
    s_and_b32 s73, s73, 131071
    s_lshl_b32 s12, s74, 12
    s_add_u32 s12, s12, s69
    s_add_u32 m0, s71, s73
    s_nop 0
    buffer_load_dwordx4 v1, s[52:55], s12 offen offset:0 sc1 lds
    buffer_load_dwordx4 v1, s[52:55], s12 offen offset:1024 sc1 lds
    buffer_load_dwordx4 v1, s[52:55], s12 offen offset:2048 sc1 lds
    buffer_load_dwordx4 v1, s[52:55], s12 offen offset:3072 sc1 lds
    s_lshl_b32 s12, s74, 17
    s_add_u32 s12, s12, s70
    s_add_u32 m0, s71, s73
    s_add_u32 m0, m0, 16384
    s_nop 0
    buffer_load_dwordx4 v10, s[24:27], s12 offen lds
    s_add_u32 m0, m0, 1024
    s_add_u32 s12, s12, 8192
    buffer_load_dwordx4 v11, s[24:27], s12 offen lds
    s_add_u32 m0, m0, 1024
    s_add_u32 s12, s12, 8192
    buffer_load_dwordx4 v10, s[24:27], s12 offen lds
    s_add_u32 m0, m0, 1024
    s_add_u32 s12, s12, 8192
    buffer_load_dwordx4 v11, s[24:27], s12 offen lds
    s_add_u32 s74, s74, 1
    s_add_u32 s73, s73, 32768
    s_and_b32 s73, s73, 131071
    s_waitcnt vmcnt(16)
    s_mov_b32 s65, 5
KF_PLP:
    s_barrier
    s_cmp_lg_u32 s8, 4
    s_cbranch_scc1 KF_PF_23
    s_branch KF_PQ_25
KF_PR_26:
    buffer_load_dword v17, v14, s[52:55], s95 offen sc0 sc1
    s_add_u32 s14, s14, 1
    s_waitcnt vmcnt(0)
    v_cmp_eq_u32 vcc, 1, v17
    s_cmp_gt_u32 s14, 0x40000
    s_cselect_b64 s[18:19], -1, vcc
KF_PQ_25:
    s_lshr_b64 s[10:11], s[18:19], 4
    s_and_b64 s[10:11], s[10:11], s[18:19]
    s_lshr_b64 s[12:13], s[10:11], 2
    s_and_b64 s[10:11], s[10:11], s[12:13]
    s_lshr_b64 s[12:13], s[10:11], 1
    s_and_b64 s[10:11], s[10:11], s[12:13]
    s_and_b64 s[10:11], s[10:11], s[66:67]
    s_cbranch_scc0 KF_PR_26
    s_ff1_i32_b64 s10, s[10:11]
    s_bitset0_b64 s[66:67], s10
    s_lshr_b32 s74, s10, 2
    s_lshr_b32 s11, s10, 3
    s_add_u32 s11, s11, 1
    v_mov_b32 v17, s11
    ds_write_b32 v18, v17
    v_add_u32 v18, 4, v18
    s_lshr_b32 s10, s75, 1
    s_and_b32 s9, s10, 4
    s_add_u32 s10, s10, s3
    s_and_b32 s10, s10, 3
    s_xor_b32 s9, s9, s3
    s_and_b32 s9, s9, 4
    s_or_b32 s10, s10, s9
    s_add_u32 s75, s75, 2
    s_lshl_b32 s10, s10, 3
    s_lshl_b64 s[66:67], 1, s10
    s_branch KF_PG_24
KF_PF_23:
KF_WQ_27:
    ds_read_b32 v17, v18
    s_waitcnt lgkmcnt(0)
    v_readfirstlane_b32 s10, v17
    s_nop 0
    s_cmp_eq_u32 s10, 0
    s_cbranch_scc1 KF_WQ_27
    v_add_u32 v18, 4, v18
    s_sub_u32 s10, s10, 1
    s_lshl_b32 s74, s10, 1
KF_PG_24:
    s_lshl_b32 s12, s74, 12
    s_add_u32 s12, s12, s69
    s_add_u32 m0, s71, s73
    s_nop 0
    buffer_load_dwordx4 v1, s[52:55], s12 offen offset:0 sc1 lds
    buffer_load_dwordx4 v1, s[52:55], s12 offen offset:1024 sc1 lds
    buffer_load_dwordx4 v1, s[52:55], s12 offen offset:2048 sc1 lds
    buffer_load_dwordx4 v1, s[52:55], s12 offen offset:3072 sc1 lds
    s_lshl_b32 s12, s74, 17
    s_add_u32 s12, s12, s70
    s_add_u32 m0, s71, s73
    s_add_u32 m0, m0, 16384
    s_nop 0
    buffer_load_dwordx4 v10, s[24:27], s12 offen lds
    s_add_u32 m0, m0, 1024
    s_add_u32 s12, s12, 8192
    buffer_load_dwordx4 v11, s[24:27], s12 offen lds
    s_add_u32 m0, m0, 1024
    s_add_u32 s12, s12, 8192
    buffer_load_dwordx4 v10, s[24:27], s12 offen lds
    s_add_u32 m0, m0, 1024
    s_add_u32 s12, s12, 8192
    buffer_load_dwordx4 v11, s[24:27], s12 offen lds
    s_add_u32 s74, s74, 1
    s_add_u32 s73, s73, 32768
    s_and_b32 s73, s73, 131071
    s_waitcnt vmcnt(16)
    s_barrier
    s_lshl_b32 s12, s74, 12
    s_add_u32 s12, s12, s69
    s_add_u32 m0, s71, s73
    s_nop 0
    buffer_load_dwordx4 v1, s[52:55], s12 offen offset:0 sc1 lds
    buffer_load_dwordx4 v1, s[52:55], s12 offen offset:1024 sc1 lds
    buffer_load_dwordx4 v1, s[52:55], s12 offen offset:2048 sc1 lds
    buffer_load_dwordx4 v1, s[52:55], s12 offen offset:3072 sc1 lds
    s_lshl_b32 s12, s74, 17
    s_add_u32 s12, s12, s70
    s_add_u32 m0, s71, s73
    s_add_u32 m0, m0, 16384
    s_nop 0
    buffer_load_dwordx4 v10, s[24:27], s12 offen lds
    s_add_u32 m0, m0, 1024
    s_add_u32 s12, s12, 8192
    buffer_load_dwordx4 v11, s[24:27], s12 offen lds
    s_add_u32 m0, m0, 1024
    s_add_u32 s12, s12, 8192
    buffer_load_dwordx4 v10, s[24:27], s12 offen lds
    s_add_u32 m0, m0, 1024
    s_add_u32 s12, s12, 8192
    buffer_load_dwordx4 v11, s[24:27], s12 offen lds
    s_add_u32 s74, s74, 1
    s_add_u32 s73, s73, 32768
    s_and_b32 s73, s73, 131071
    s_sub_u32 s65, s65, 1
    s_cmp_lg_u32 s65, 0
    s_waitcnt vmcnt(16)
    s_cbranch_scc1 KF_PLP
    s_barrier
    s_waitcnt vmcnt(8)
    s_barrier
    s_waitcnt vmcnt(0)
    s_barrier
KF_END:
    s_endpgm
CODE_END:
.section .rodata,"a"
.p2align 6
.amdhsa_kernel concat_heads__grouped_kv_mqa__softmax_full_mha__prompt_kernel
  .amdhsa_next_free_vgpr 256
  .amdhsa_next_free_sgpr 102
  .amdhsa_accum_offset 256
  .amdhsa_group_segment_fixed_size 0
  .amdhsa_kernarg_size 88
  .amdhsa_user_sgpr_count 2
  .amdhsa_user_sgpr_kernarg_segment_ptr 1
  .amdhsa_system_sgpr_workgroup_id_x 1
  .amdhsa_float_denorm_mode_32 3
.end_amdhsa_kernel
```
